```python
import torch

def _softmax(x, axis=-1):
    return torch.softmax(x, dim=axis)
def _gelu(x):
    return torch.nn.functional.gelu(x, approximate="tanh")
def _silu(x):
    return torch.nn.functional.silu(x)
def _sigmoid(x):
    return torch.sigmoid(x)
def _layernorm(x, axis=-1, eps=1e-5):
    m = x.mean(dim=axis, keepdim=True)
    v = x.var(dim=axis, keepdim=True, unbiased=False)
    return (x - m) / torch.sqrt(v + eps)
def _scatter_add(tgt, idx, src, axis=0):
    return tgt.clone().index_add_(axis, idx, src)
def _segment_sum(src, seg, n):
    out = torch.zeros((n,) + src.shape[1:], dtype=src.dtype)
    return out.index_add_(0, seg, src)
def _pad(x, pw):
    flat = tuple(v for pair in reversed(pw) for v in pair)
    return torch.nn.functional.pad(x, flat)

kernel_name = 'gated_mix__spectral_gfnet__swiglu_ffn__prompt'

def setup_inputs():

    _w = (lambda a: (lambda t: t.to(torch.bfloat16) if t.is_floating_point() else t)(torch.as_tensor(a)))
    def _A_setup():
        B, S, D = 1, 2048, 640
        Df = D // 2 + 1
        return {
            "x": _w((lambda *s: torch.randn(*s, dtype=torch.bfloat16) * 0.05)(B, S, D)),
            "w_r": _w((lambda *s: torch.randn(*s, dtype=torch.bfloat16) * 0.8)(S, Df) * 0.02),
            "w_i": _w((lambda *s: torch.randn(*s, dtype=torch.bfloat16) * 0.8)(S, Df) * 0.02),
        }
    _A_in = _A_setup()

    def _B_setup():
        B, S, D, F = 1, 2048, 640, 1536
        return {
            "x": _w((lambda *s: torch.randn(*s, dtype=torch.bfloat16) * 0.05)(B, S, D)),
            "w_gate": _w((lambda *s: torch.randn(*s, dtype=torch.bfloat16) * 0.05)(D, F)),
            "w_up": _w((lambda *s: torch.randn(*s, dtype=torch.bfloat16) * 0.05)(D, F)),
            "w_down": _w((lambda *s: torch.randn(*s, dtype=torch.bfloat16) * 0.05)(F, D)),
        }
    _B_in = _B_setup()

    return {
        "A_x": _A_in["x"],
        "A_w_r": _A_in["w_r"],
        "A_w_i": _A_in["w_i"],
        "B_x": _B_in["x"],
        "B_w_gate": _B_in["w_gate"],
        "B_w_up": _B_in["w_up"],
        "B_w_down": _B_in["w_down"],
        "gate_w": _w((lambda *s: torch.randn(*s, dtype=torch.bfloat16) * 0.05)(640) * 16.0),
    }

def reference(A_x, A_w_r, A_w_i, B_x, B_w_gate, B_w_up, B_w_down, gate_w):
    def _A_ref(x, w_r, w_i):
        B, S, D = x.shape
        X = (lambda x, axes=(-2,-1): torch.fft.rfft2(x.float(), dim=axes))(x, axes=(-2, -1))
        W = w_r + 1j * w_i
        X = X * W
        y = (lambda x, s, axes=(-2,-1): torch.fft.irfft2(x, s=s, dim=axes).to(torch.bfloat16))(X, (S, D), axes=(-2, -1))
        return y

    def _B_ref(x, w_gate, w_up, w_down):
        g = _silu(x @ w_gate)
        u = x @ w_up
        return (g * u) @ w_down

    x = A_x
    g = _sigmoid((x * gate_w).sum(-1, keepdims=True))
    a = _A_ref(x, A_w_r, A_w_i)
    b = _B_ref(x, B_w_gate, B_w_up, B_w_down)
    return g * a + (1 - g) * b
```

```asm
; @launch grid=(256,1,1) block=(256,1,1) lds=163840
.amdgcn_target "amdgcn-amd-amdhsa--gfx950"
.text
.globl gated_mix__spectral_gfnet__swiglu_ffn__prompt_kernel
.p2align 8
.type gated_mix__spectral_gfnet__swiglu_ffn__prompt_kernel,@function
gated_mix__spectral_gfnet__swiglu_ffn__prompt_kernel:
  s_cmp_ge_u32 s2, 256
  s_cbranch_scc1 K_exit
  s_load_dwordx16 s[68:83], s[0:1], 0
  s_load_dwordx4 s[84:87], s[0:1], 64
  s_load_dwordx2 s[88:89], s[0:1], 80
  s_getpc_b64 s[4:5]
K_pc:
  s_and_b32 s5, s5, 0xffff
  s_mov_b32 s6, K_exit-K_pc
  s_mov_b32 s7, 0x20000
  v_lshlrev_b32 v4, 7, v0
  s_mov_b32 s28, 0
  buffer_load_dword v229, v4, s[4:7], s28 offen
  s_mov_b32 s98, s2
  s_and_b32 s3, s2, 7
  s_lshl_b32 s3, s3, 1
  s_bfe_u32 s28, s2, 65539
  s_add_u32 s3, s3, s28
  s_and_b32 s28, s2, 0xf0
  s_add_u32 s3, s3, s28
  v_lshrrev_b32 v4, 6, v0
  s_nop 0
  v_readfirstlane_b32 s20, v4
  s_waitcnt lgkmcnt(0)
  s_load_dword s90, s[88:89], 0
  s_mov_b32 s92, s88
  s_and_b32 s93, s89, 0xffff
  s_mov_b32 s94, 0xe000
  s_mov_b32 s95, 0x20000
  v_and_b32 v1, 63, v0
  v_and_b32 v2, 31, v1
  v_lshrrev_b32 v3, 5, v1
  s_mov_b32 s32, s68
  s_and_b32 s33, s69, 0xffff
  s_mov_b32 s34, 0x280000
  s_mov_b32 s35, 0x20000
  s_lshl_b32 s28, s3, 2
  s_add_u32 s28, s28, s20
  s_mul_i32 s28, s28, 1280
  s_mul_i32 s29, s20, 3072
  s_add_u32 m0, s29, 122880
  v_lshlrev_b32 v4, 4, v1
  buffer_load_dwordx4 v4, s[32:35], s28 offen lds
  v_add_u32 v5, 0, v4
  v_add_u32 v6, 1309440, v4
  v_cmp_gt_u32 vcc, 16, v1
  s_nop 1
  v_cndmask_b32 v5, v6, v5, vcc
  buffer_load_dwordx4 v5, s[32:35], s28 offen offset:1024 lds
  v_add_u32 v5, 1309440, v4
  v_mov_b32 v6, 0x40000000
  v_cmp_gt_u32 vcc, 32, v1
  s_nop 1
  v_cndmask_b32 v5, v6, v5, vcc
  buffer_load_dwordx4 v5, s[32:35], s28 offen offset:2048 lds
  s_mov_b32 s40, s70
  s_and_b32 s41, s71, 0xffff
  s_mov_b32 s42, 0x141000
  s_mov_b32 s43, 0x20000
  s_mov_b32 s44, s72
  s_and_b32 s45, s73, 0xffff
  s_mov_b32 s46, 0x141000
  s_mov_b32 s47, 0x20000
  s_and_b32 s28, s98, 63
  s_lshl_b32 s28, s28, 5
  s_and_b32 s29, s20, 1
  s_lshl_b32 s30, s29, 4
  s_add_u32 s28, s28, s30
  s_mul_i32 s30, s29, 3104
  s_lshr_b32 s31, s20, 1
  s_mul_i32 s31, s31, 6208
  s_add_u32 s30, s30, s31
  s_add_u32 s30, s30, 137216
  s_lshr_b32 s29, s98, 6
  s_mul_i32 s29, s29, 162
  s_cmp_lt_u32 s20, 2
  s_cselect_b32 s4, s40, s44
  s_cselect_b32 s5, s41, s45
  s_mov_b32 s6, 0x141000
  s_mov_b32 s7, 0x20000
  v_mul_u32_u24 v6, 5462, v1
  v_lshrrev_b32 v5, 16, v6
  v_mul_u32_u24 v7, 12, v5
  v_sub_u32 v7, v1, v7
  v_add_u32 v5, s28, v5
  v_mul_u32_u24 v5, 642, v5
  v_add_u32 v5, s29, v5
  s_mov_b32 exec_hi, 0xffff
  v_add_u32 v6, 0, v5
  v_and_b32 v6, -16, v6
  v_lshl_add_u32 v6, v7, 4, v6
  s_add_u32 m0, s30, 0
  s_nop 0
  buffer_load_dwordx4 v6, s[4:7], 0 offen lds
  v_add_u32 v6, 2568, v5
  v_and_b32 v6, -16, v6
  v_lshl_add_u32 v6, v7, 4, v6
  s_add_u32 m0, s30, 768
  s_nop 0
  buffer_load_dwordx4 v6, s[4:7], 0 offen lds
  v_add_u32 v6, 5136, v5
  v_and_b32 v6, -16, v6
  v_lshl_add_u32 v6, v7, 4, v6
  s_add_u32 m0, s30, 1552
  s_nop 0
  buffer_load_dwordx4 v6, s[4:7], 0 offen lds
  v_add_u32 v6, 7704, v5
  v_and_b32 v6, -16, v6
  v_lshl_add_u32 v6, v7, 4, v6
  s_add_u32 m0, s30, 2320
  s_nop 0
  buffer_load_dwordx4 v6, s[4:7], 0 offen lds
  s_mov_b64 exec, -1
  s_mov_b32 s52, s80
  s_and_b32 s53, s81, 0xffff
  s_mov_b32 s54, 0x1e0000
  s_mov_b32 s55, 0x20000
  s_mul_i32 s30, s98, 52429
  s_lshr_b32 s30, s30, 18
  s_mul_i32 s31, s30, 5
  s_sub_u32 s31, s98, s31
  s_lshl_b32 s28, s30, 5
  s_lshl_b32 s29, s20, 3
  s_add_u32 s28, s28, s29
  s_mul_i32 s28, s28, 1280
  s_lshl_b32 s29, s31, 8
  s_add_u32 s28, s28, s29
  v_lshrrev_b32 v5, 4, v1
  v_mul_u32_u24 v5, 1280, v5
  v_and_b32 v6, 15, v1
  v_lshl_add_u32 v5, v6, 4, v5
  s_lshl_b32 s29, s20, 11
  s_add_u32 m0, s29, 155648
  v_add_u32 v6, 4096, v5
  buffer_load_dwordx4 v5, s[52:55], s28 offen lds
  buffer_load_dwordx4 v6, s[52:55], s28 offen offset:1024 lds
  s_mov_b32 s60, s82
  s_and_b32 s61, s83, 0xffff
  s_mov_b32 s62, 0x500
  s_mov_b32 s63, 0x20000
  s_lshl_b32 s28, s20, 10
  s_min_u32 s28, s28, 1024
  s_add_u32 m0, s28, 135168
  s_nop 0
  buffer_load_dwordx4 v4, s[60:63], s28 offen lds
  s_cmp_lt_u32 s20, 2
  s_cselect_b32 s4, s76, s78
  s_cselect_b32 s5, s77, s79
  s_and_b32 s5, s5, 0xffff
  s_mov_b32 s6, 0x1e0000
  s_mov_b32 s7, 0x20000
  s_lshr_b32 s28, s98, 3
  s_lshl_b32 s28, s28, 1
  s_and_b32 s29, s20, 1
  s_add_u32 s28, s28, s29
  s_mul_i32 s28, s28, 60
  v_and_b32 v56, 63, v0
  v_min_u32 v56, 59, v56
  v_add_u32 v56, s28, v56
  v_mul_u32_u24 v57, 10923, v56
  v_lshrrev_b32 v57, 16, v57
  v_mul_u32_u24 v58, 6, v57
  v_sub_u32 v58, v56, v58
  v_mul_u32_u24 v57, 3072, v57
  v_lshl_add_u32 v57, v58, 7, v57
  s_lshr_b32 s28, s98, 1
  s_and_b32 s28, s28, 3
  s_mul_i32 s28, s28, 768
  buffer_load_dword v229, v57, s[4:7], s28 offen
  v_cvt_f32_u32 v4, v2
  v_cvt_f32_u32 v5, v3
  v_mul_f32 v6, 0x3d000000, v4
  v_mul_f32 v7, 4.0, v5
  v_mul_f32 v8, v7, v6
  v_fmamk_f32 v9, v6, 0x0, v8
  v_fract_f32 v9, v9
  v_sin_f32 v10, v9
  v_cos_f32 v11, v9
  s_nop 0
  v_cvt_pk_bf16_f32 v12, v11, v10
  v_cvt_pk_bf16_f32 v13, -v10, v11
  v_accvgpr_write_b32 a216, v12
  v_accvgpr_write_b32 a232, v13
  v_fmamk_f32 v9, v6, 0x3f800000, v8
  v_fract_f32 v9, v9
  v_sin_f32 v10, v9
  v_cos_f32 v11, v9
  s_nop 0
  v_cvt_pk_bf16_f32 v12, v11, v10
  v_cvt_pk_bf16_f32 v13, -v10, v11
  v_accvgpr_write_b32 a217, v12
  v_accvgpr_write_b32 a233, v13
  v_fmamk_f32 v9, v6, 0x40000000, v8
  v_fract_f32 v9, v9
  v_sin_f32 v10, v9
  v_cos_f32 v11, v9
  s_nop 0
  v_cvt_pk_bf16_f32 v12, v11, v10
  v_cvt_pk_bf16_f32 v13, -v10, v11
  v_accvgpr_write_b32 a218, v12
  v_accvgpr_write_b32 a234, v13
  v_fmamk_f32 v9, v6, 0x40400000, v8
  v_fract_f32 v9, v9
  v_sin_f32 v10, v9
  v_cos_f32 v11, v9
  s_nop 0
  v_cvt_pk_bf16_f32 v12, v11, v10
  v_cvt_pk_bf16_f32 v13, -v10, v11
  v_accvgpr_write_b32 a219, v12
  v_accvgpr_write_b32 a235, v13
  v_fmamk_f32 v9, v6, 0x41000000, v8
  v_fract_f32 v9, v9
  v_sin_f32 v10, v9
  v_cos_f32 v11, v9
  s_nop 0
  v_cvt_pk_bf16_f32 v12, v11, v10
  v_cvt_pk_bf16_f32 v13, -v10, v11
  v_accvgpr_write_b32 a220, v12
  v_accvgpr_write_b32 a236, v13
  v_fmamk_f32 v9, v6, 0x41100000, v8
  v_fract_f32 v9, v9
  v_sin_f32 v10, v9
  v_cos_f32 v11, v9
  s_nop 0
  v_cvt_pk_bf16_f32 v12, v11, v10
  v_cvt_pk_bf16_f32 v13, -v10, v11
  v_accvgpr_write_b32 a221, v12
  v_accvgpr_write_b32 a237, v13
  v_fmamk_f32 v9, v6, 0x41200000, v8
  v_fract_f32 v9, v9
  v_sin_f32 v10, v9
  v_cos_f32 v11, v9
  s_nop 0
  v_cvt_pk_bf16_f32 v12, v11, v10
  v_cvt_pk_bf16_f32 v13, -v10, v11
  v_accvgpr_write_b32 a222, v12
  v_accvgpr_write_b32 a238, v13
  v_fmamk_f32 v9, v6, 0x41300000, v8
  v_fract_f32 v9, v9
  v_sin_f32 v10, v9
  v_cos_f32 v11, v9
  s_nop 0
  v_cvt_pk_bf16_f32 v12, v11, v10
  v_cvt_pk_bf16_f32 v13, -v10, v11
  v_accvgpr_write_b32 a223, v12
  v_accvgpr_write_b32 a239, v13
  v_fmamk_f32 v9, v6, 0x41800000, v8
  v_fract_f32 v9, v9
  v_sin_f32 v10, v9
  v_cos_f32 v11, v9
  s_nop 0
  v_cvt_pk_bf16_f32 v12, v11, v10
  v_cvt_pk_bf16_f32 v13, -v10, v11
  v_accvgpr_write_b32 a224, v12
  v_accvgpr_write_b32 a240, v13
  v_fmamk_f32 v9, v6, 0x41880000, v8
  v_fract_f32 v9, v9
  v_sin_f32 v10, v9
  v_cos_f32 v11, v9
  s_nop 0
  v_cvt_pk_bf16_f32 v12, v11, v10
  v_cvt_pk_bf16_f32 v13, -v10, v11
  v_accvgpr_write_b32 a225, v12
  v_accvgpr_write_b32 a241, v13
  v_fmamk_f32 v9, v6, 0x41900000, v8
  v_fract_f32 v9, v9
  v_sin_f32 v10, v9
  v_cos_f32 v11, v9
  s_nop 0
  v_cvt_pk_bf16_f32 v12, v11, v10
  v_cvt_pk_bf16_f32 v13, -v10, v11
  v_accvgpr_write_b32 a226, v12
  v_accvgpr_write_b32 a242, v13
  v_fmamk_f32 v9, v6, 0x41980000, v8
  v_fract_f32 v9, v9
  v_sin_f32 v10, v9
  v_cos_f32 v11, v9
  s_nop 0
  v_cvt_pk_bf16_f32 v12, v11, v10
  v_cvt_pk_bf16_f32 v13, -v10, v11
  v_accvgpr_write_b32 a227, v12
  v_accvgpr_write_b32 a243, v13
  v_fmamk_f32 v9, v6, 0x41c00000, v8
  v_fract_f32 v9, v9
  v_sin_f32 v10, v9
  v_cos_f32 v11, v9
  s_nop 0
  v_cvt_pk_bf16_f32 v12, v11, v10
  v_cvt_pk_bf16_f32 v13, -v10, v11
  v_accvgpr_write_b32 a228, v12
  v_accvgpr_write_b32 a244, v13
  v_fmamk_f32 v9, v6, 0x41c80000, v8
  v_fract_f32 v9, v9
  v_sin_f32 v10, v9
  v_cos_f32 v11, v9
  s_nop 0
  v_cvt_pk_bf16_f32 v12, v11, v10
  v_cvt_pk_bf16_f32 v13, -v10, v11
  v_accvgpr_write_b32 a229, v12
  v_accvgpr_write_b32 a245, v13
  v_fmamk_f32 v9, v6, 0x41d00000, v8
  v_fract_f32 v9, v9
  v_sin_f32 v10, v9
  v_cos_f32 v11, v9
  s_nop 0
  v_cvt_pk_bf16_f32 v12, v11, v10
  v_cvt_pk_bf16_f32 v13, -v10, v11
  v_accvgpr_write_b32 a230, v12
  v_accvgpr_write_b32 a246, v13
  v_fmamk_f32 v9, v6, 0x41d80000, v8
  v_fract_f32 v9, v9
  v_sin_f32 v10, v9
  v_cos_f32 v11, v9
  s_nop 0
  v_cvt_pk_bf16_f32 v12, v11, v10
  v_cvt_pk_bf16_f32 v13, -v10, v11
  v_accvgpr_write_b32 a231, v12
  v_accvgpr_write_b32 a247, v13
  v_mul_f32 v6, 0x3b4ccccd, v4
  v_mul_f32 v8, v7, v6
  v_fmamk_f32 v9, v6, 0x0, v8
  v_cos_f32 v192, v9
  v_sin_f32 v198, -v9
  v_fmamk_f32 v9, v6, 0x3f800000, v8
  v_cos_f32 v193, v9
  v_sin_f32 v199, -v9
  v_fmamk_f32 v9, v6, 0x40000000, v8
  v_cos_f32 v194, v9
  v_sin_f32 v200, -v9
  v_fmamk_f32 v9, v6, 0x40400000, v8
  v_cos_f32 v195, v9
  v_sin_f32 v201, -v9
  v_fmamk_f32 v9, v6, 0x41000000, v8
  v_cos_f32 v196, v9
  v_sin_f32 v202, -v9
  v_fmamk_f32 v9, v6, 0x41100000, v8
  v_cos_f32 v197, v9
  v_sin_f32 v203, -v9
  v_lshrrev_b32 v9, 3, v2
  v_lshlrev_b32 v9, 2, v9
  v_bfe_u32 v10, v2, 2, 1
  v_lshl_add_u32 v9, v10, 1, v9
  v_bfe_u32 v10, v2, 1, 1
  v_add_u32 v9, v9, v10
  v_cmp_gt_u32 s[28:29], 10, v9
  v_cvt_f32_u32 v9, v9
  v_mul_f32 v9, 0x3dcccccd, v9
  v_and_b32 v10, 1, v2
  v_cvt_f32_u32 v10, v10
  v_mul_f32 v10, 0x3e800000, v10
  v_fma_f32 v10, v7, v9, v10
  v_cmp_eq_u32 vcc, 0, v3
  s_nop 0
  s_and_b64 s[30:31], vcc, s[28:29]
  v_fmamk_f32 v11, v9, 0x0, v10
  v_fract_f32 v11, v11
  v_cos_f32 v12, v11
  v_sin_f32 v13, v11
  s_nop 0
  v_cvt_pk_bf16_f32 v12, v12, v13
  v_cndmask_b32 v12, 0, v12, s[28:29]
  v_accvgpr_write_b32 a248, v12
  v_fmamk_f32 v11, v9, 0x3f800000, v10
  v_fract_f32 v11, v11
  v_cos_f32 v12, v11
  v_sin_f32 v13, v11
  s_nop 0
  v_cvt_pk_bf16_f32 v12, v12, v13
  v_cndmask_b32 v12, 0, v12, s[28:29]
  v_accvgpr_write_b32 a249, v12
  v_fmamk_f32 v11, v9, 0x40000000, v10
  v_fract_f32 v11, v11
  v_cos_f32 v12, v11
  v_sin_f32 v13, v11
  s_nop 0
  v_cvt_pk_bf16_f32 v12, v12, v13
  v_cndmask_b32 v12, 0, v12, s[28:29]
  v_accvgpr_write_b32 a250, v12
  v_fmamk_f32 v11, v9, 0x40400000, v10
  v_fract_f32 v11, v11
  v_cos_f32 v12, v11
  v_sin_f32 v13, v11
  s_nop 0
  v_cvt_pk_bf16_f32 v12, v12, v13
  v_cndmask_b32 v12, 0, v12, s[28:29]
  v_accvgpr_write_b32 a251, v12
  v_fmamk_f32 v11, v9, 0x41000000, v10
  v_fract_f32 v11, v11
  v_cos_f32 v12, v11
  v_sin_f32 v13, v11
  s_nop 0
  v_cvt_pk_bf16_f32 v12, v12, v13
  v_cndmask_b32 v12, 0, v12, s[30:31]
  v_accvgpr_write_b32 a252, v12
  v_fmamk_f32 v11, v9, 0x41100000, v10
  v_fract_f32 v11, v11
  v_cos_f32 v12, v11
  v_sin_f32 v13, v11
  s_nop 0
  v_cvt_pk_bf16_f32 v12, v12, v13
  v_cndmask_b32 v12, 0, v12, s[30:31]
  v_accvgpr_write_b32 a253, v12
  v_accvgpr_write_b32 a254, 0
  v_accvgpr_write_b32 a255, 0
  s_and_b32 s28, s98, 1
  s_lshl_b32 s28, s28, 3
  s_lshr_b32 s29, s98, 3
  s_and_b32 s29, s29, 7
  s_add_u32 s25, s28, s29
  s_lshr_b32 s29, s98, 1
  s_and_b32 s29, s29, 3
  s_lshl_b32 s29, s29, 2
  s_lshr_b32 s30, s98, 6
  s_add_u32 s26, s29, s30
  s_mov_b32 s8, s68
  s_and_b32 s9, s69, 0xffff
  s_mov_b32 s10, 0x280000
  s_mov_b32 s11, 0x20000
  s_cmp_lt_u32 s20, 2
  s_cselect_b32 s12, s76, s78
  s_cselect_b32 s13, s77, s79
  s_and_b32 s13, s13, 0xffff
  s_mov_b32 s14, 0x1e0000
  s_mov_b32 s15, 0x20000
  v_and_b32 v56, 63, v0
  s_lshl_b32 s28, s25, 7
  s_lshl_b32 s29, s20, 5
  s_add_u32 s28, s28, s29
  s_mul_i32 s28, s28, 1280
  v_lshrrev_b32 v57, 3, v56
  v_mul_u32_u24 v57, 1280, v57
  v_add_u32 v57, s28, v57
  v_lshrrev_b32 v58, 4, v56
  v_xor_b32 v58, v58, v56
  v_and_b32 v58, 7, v58
  v_lshl_add_u32 v230, v58, 4, v57
  v_xor_b32 v58, 4, v58
  v_lshl_add_u32 v231, v58, 4, v57
  v_add_u32 v231, 9216, v231
  v_add_u32 v232, 18432, v230
  v_add_u32 v233, 18432, v231
  s_and_b32 s28, s20, 1
  s_mul_i32 s28, s28, 49152
  s_mul_i32 s29, s26, 192
  s_add_u32 s28, s28, s29
  s_lshr_b32 s29, s20, 1
  s_mul_i32 s29, s29, 10
  v_add_u32 v57, 0, v56
  v_mul_u32_u24 v58, 5462, v57
  v_lshrrev_b32 v58, 16, v58
  v_mul_u32_u24 v59, 12, v58
  v_sub_u32 v59, v57, v59
  v_add_u32 v59, s29, v59
  v_subrev_u32 v60, 12, v59
  v_min_u32 v59, v59, v60
  v_mul_u32_u24 v58, 3072, v58
  v_lshl_add_u32 v58, v59, 4, v58
  v_add_u32 v58, s28, v58
  v_subrev_u32 v234, 0, v58
  v_add_u32 v57, 64, v56
  v_mul_u32_u24 v58, 5462, v57
  v_lshrrev_b32 v58, 16, v58
  v_mul_u32_u24 v59, 12, v58
  v_sub_u32 v59, v57, v59
  v_add_u32 v59, s29, v59
  v_subrev_u32 v60, 12, v59
  v_min_u32 v59, v59, v60
  v_mul_u32_u24 v58, 3072, v58
  v_lshl_add_u32 v58, v59, 4, v58
  v_add_u32 v58, s28, v58
  v_subrev_u32 v235, 1024, v58
  v_add_u32 v57, 128, v56
  v_mul_u32_u24 v58, 5462, v57
  v_lshrrev_b32 v58, 16, v58
  v_mul_u32_u24 v59, 12, v58
  v_sub_u32 v59, v57, v59
  v_add_u32 v59, s29, v59
  v_subrev_u32 v60, 12, v59
  v_min_u32 v59, v59, v60
  v_mul_u32_u24 v58, 3072, v58
  v_lshl_add_u32 v58, v59, 4, v58
  v_add_u32 v58, s28, v58
  v_subrev_u32 v236, 2048, v58
  s_lshl_b32 s23, s20, 12
  s_mul_i32 s24, s20, 3072
  s_add_u32 s24, s24, 49152
  s_add_u32 s36, s88, 0x800000
  s_addc_u32 s37, s89, 0
  s_and_b32 s37, s37, 0xffff
  s_mov_b32 s38, 0x288000
  s_mov_b32 s39, 0x20000
  s_add_u32 s48, s88, 0xc00000
  s_addc_u32 s49, s89, 0
  s_and_b32 s49, s49, 0xffff
  s_mov_b32 s50, 0x288000
  s_mov_b32 s51, 0x20000
  s_add_u32 s56, s88, 0x1600000
  s_addc_u32 s57, s89, 0
  s_and_b32 s57, s57, 0xffff
  s_mov_b32 s58, 0x1e0000
  s_mov_b32 s59, 0x20000
  s_add_u32 s64, s88, 0x4000
  s_addc_u32 s65, s89, 0
  s_and_b32 s65, s65, 0xffff
  s_mov_b32 s66, 0x2000
  s_mov_b32 s67, 0x20000
  v_and_b32 v56, 63, v0
  s_lshr_b32 s28, s20, 1
  s_lshl_b32 s28, s28, 13
  v_and_b32 v57, 31, v56
  v_lshrrev_b32 v58, 5, v56
  v_bfe_u32 v59, v57, 1, 3
  v_xor_b32 v59, v59, v58
  v_lshlrev_b32 v60, 7, v57
  v_add_u32 v60, s28, v60
  v_lshl_add_u32 v237, v59, 4, v60
  v_xor_b32 v238, 32, v237
  v_xor_b32 v239, 64, v237
  v_xor_b32 v240, 96, v237
  s_and_b32 s28, s20, 1
  s_mul_i32 s29, s28, 96
  s_add_u32 s29, s29, 49152
  v_lshrrev_b32 v57, 5, v56
  v_lshlrev_b32 v57, 3, v57
  v_bfe_u32 v58, v56, 2, 2
  v_add_u32 v57, v57, v58
  v_mul_u32_u24 v57, 192, v57
  v_bfe_u32 v58, v56, 4, 1
  v_lshl_add_u32 v57, v58, 4, v57
  v_and_b32 v58, 1, v56
  v_lshl_add_u32 v57, v58, 3, v57
  v_bfe_u32 v58, v56, 1, 1
  v_mul_u32_u24 v59, 6176, v58
  v_add_u32 v57, v57, v59
  v_add_u32 v241, s29, v57
  s_mul_i32 s29, s28, 192
  v_mul_u32_u24 v59, s29, v58
  v_sub_u32 v242, v241, v59
  v_cvt_f32_u32 v243, v2
  v_cvt_f32_u32 v244, v3
  v_mul_f32 v244, 4.0, v244
  v_mul_f32 v245, 0x3a800000, v243
  v_mul_f32 v246, v244, v245
  v_fmamk_f32 v247, v245, 0x0, v246
  v_cos_f32 v160, v247
  v_sin_f32 v176, -v247
  v_fmamk_f32 v247, v245, 0x3f800000, v246
  v_cos_f32 v161, v247
  v_sin_f32 v177, -v247
  v_fmamk_f32 v247, v245, 0x40000000, v246
  v_cos_f32 v162, v247
  v_sin_f32 v178, -v247
  v_fmamk_f32 v247, v245, 0x40400000, v246
  v_cos_f32 v163, v247
  v_sin_f32 v179, -v247
  v_fmamk_f32 v247, v245, 0x41000000, v246
  v_cos_f32 v164, v247
  v_sin_f32 v180, -v247
  v_fmamk_f32 v247, v245, 0x41100000, v246
  v_cos_f32 v165, v247
  v_sin_f32 v181, -v247
  v_fmamk_f32 v247, v245, 0x41200000, v246
  v_cos_f32 v166, v247
  v_sin_f32 v182, -v247
  v_fmamk_f32 v247, v245, 0x41300000, v246
  v_cos_f32 v167, v247
  v_sin_f32 v183, -v247
  v_fmamk_f32 v247, v245, 0x41800000, v246
  v_cos_f32 v168, v247
  v_sin_f32 v184, -v247
  v_fmamk_f32 v247, v245, 0x41880000, v246
  v_cos_f32 v169, v247
  v_sin_f32 v185, -v247
  v_fmamk_f32 v247, v245, 0x41900000, v246
  v_cos_f32 v170, v247
  v_sin_f32 v186, -v247
  v_fmamk_f32 v247, v245, 0x41980000, v246
  v_cos_f32 v171, v247
  v_sin_f32 v187, -v247
  v_fmamk_f32 v247, v245, 0x41c00000, v246
  v_cos_f32 v172, v247
  v_sin_f32 v188, -v247
  v_fmamk_f32 v247, v245, 0x41c80000, v246
  v_cos_f32 v173, v247
  v_sin_f32 v189, -v247
  v_fmamk_f32 v247, v245, 0x41d00000, v246
  v_cos_f32 v174, v247
  v_sin_f32 v190, -v247
  v_fmamk_f32 v247, v245, 0x41d80000, v246
  v_cos_f32 v175, v247
  v_sin_f32 v191, -v247
  v_and_b32 v4, 3, v0
  v_mul_u32_u24 v5, 5184, v4
  v_add_u32 v5, 98304, v5
  v_lshrrev_b32 v7, 2, v0
  v_lshl_add_u32 v112, v7, 3, v5
  v_sub_u32 v8, 192, v7
  v_lshl_add_u32 v114, v8, 3, v5
  v_add_u32 v9, 1024, v114
  v_cmp_eq_u32 vcc, 0, v7
  s_nop 1
  v_cndmask_b32 v113, v9, v5, vcc
  s_lshl_b32 s28, s3, 2
  v_add_u32 v6, s28, v4
  v_cvt_f32_u32 v9, v6
  v_mul_f32 v9, 0x3a000000, v9
  v_cos_f32 v124, v9
  v_sin_f32 v125, -v9
  v_lshrrev_b32 v10, 1, v7
  v_lshlrev_b32 v10, 15, v10
  v_and_b32 v11, 1, v7
  v_lshl_add_u32 v10, v11, 3, v10
  v_lshl_add_u32 v115, v6, 4, v10
  v_mov_b32 v11, 0x40000000
  v_cmp_gt_u32 vcc, 34, v7
  s_nop 1
  v_cndmask_b32 v116, v11, v115, vcc
  v_cvt_f32_u32 v9, v7
  v_add_f32 v10, 0x0, v9
  v_mul_f32 v10, 0x3acccccd, v10
  v_sin_f32 v118, -v10
  v_cos_f32 v10, v10
  s_nop 0
  v_sub_f32 v119, 0, v10
  v_add_f32 v10, 0x42800000, v9
  v_mul_f32 v10, 0x3acccccd, v10
  v_sin_f32 v120, -v10
  v_cos_f32 v10, v10
  s_nop 0
  v_sub_f32 v121, 0, v10
  v_add_f32 v10, 0x43000000, v9
  v_mul_f32 v10, 0x3acccccd, v10
  v_sin_f32 v122, -v10
  v_cos_f32 v10, v10
  s_nop 0
  v_sub_f32 v123, 0, v10
  v_bfe_u32 v5, v0, 2, 1
  v_lshrrev_b32 v6, 3, v0
  v_mul_u32_u24 v7, 1552, v4
  v_mul_u32_u24 v8, 192, v5
  v_add_u32 v7, v7, v8
  v_lshl_add_u32 v7, v6, 1, v7
  v_add_u32 v7, 137216, v7
  s_lshr_b32 s28, s98, 6
  v_add_u32 v8, s28, v5
  v_lshlrev_b32 v8, 1, v8
  v_add_u32 v9, 0, v8
  v_and_b32 v9, 15, v9
  v_add_u32 v126, v7, v9
  v_add_u32 v9, 4, v8
  v_and_b32 v9, 15, v9
  v_add_u32 v127, v7, v9
  v_add_u32 v9, 8, v8
  v_and_b32 v9, 15, v9
  v_add_u32 v128, v7, v9
  v_add_u32 v9, 12, v8
  v_and_b32 v9, 15, v9
  v_add_u32 v129, v7, v9
  s_mul_i32 s29, s28, 81
  s_and_b32 s30, s98, 63
  s_lshl_b32 s30, s30, 6
  v_lshlrev_b32 v7, 14, v5
  v_lshl_add_u32 v7, v4, 4, v7
  v_add_u32 v7, s30, v7
  v_mov_b32 v14, 0x40000000
  v_add_u32 v8, 0, v6
  v_add_u32 v9, s29, v8
  v_sub_u32 v10, 320, v9
  v_cmp_lt_u32 vcc, 160, v9
  s_nop 1
  v_cndmask_b32 v11, v9, v10, vcc
  v_cndmask_b32_e64 v10, 0, 1, vcc
  v_and_b32 v12, 1, v11
  v_lshl_add_u32 v10, v12, 1, v10
  v_lshrrev_b32 v11, 1, v11
  v_lshl_add_u32 v11, v11, 3, v10
  v_lshl_add_u32 v11, v11, 12, v7
  v_mov_b32 v130, v11
  v_add_u32 v8, 32, v6
  v_add_u32 v9, s29, v8
  v_sub_u32 v10, 320, v9
  v_cmp_lt_u32 vcc, 160, v9
  s_nop 1
  v_cndmask_b32 v11, v9, v10, vcc
  v_cndmask_b32_e64 v10, 0, 1, vcc
  v_and_b32 v12, 1, v11
  v_lshl_add_u32 v10, v12, 1, v10
  v_lshrrev_b32 v11, 1, v11
  v_lshl_add_u32 v11, v11, 3, v10
  v_lshl_add_u32 v11, v11, 12, v7
  v_mov_b32 v131, v11
  v_add_u32 v8, 64, v6
  v_add_u32 v9, s29, v8
  v_sub_u32 v10, 320, v9
  v_cmp_lt_u32 vcc, 160, v9
  s_nop 1
  v_cndmask_b32 v11, v9, v10, vcc
  v_cndmask_b32_e64 v10, 0, 1, vcc
  v_and_b32 v12, 1, v11
  v_lshl_add_u32 v10, v12, 1, v10
  v_lshrrev_b32 v11, 1, v11
  v_lshl_add_u32 v11, v11, 3, v10
  v_lshl_add_u32 v11, v11, 12, v7
  v_cmp_gt_u32 vcc, 81, v8
  s_nop 1
  v_cndmask_b32 v11, v14, v11, vcc
  v_cmp_ge_u32 vcc, 320, v9
  s_nop 1
  v_cndmask_b32 v132, v14, v11, vcc
  v_add_u32 v11, 4096, v11
  v_cmp_eq_u32 vcc, 160, v9
  s_nop 1
  v_cndmask_b32 v133, v14, v11, vcc
  v_bfe_u32 v4, v1, 5, 1
  v_lshlrev_b32 v4, 4, v4
  v_bfe_u32 v5, v1, 4, 1
  v_lshl_add_u32 v4, v5, 2, v4
  v_bfe_u32 v5, v1, 2, 2
  v_add_u32 v4, v4, v5
  v_lshlrev_b32 v4, 8, v4
  v_and_b32 v5, 3, v1
  v_lshl_add_u32 v4, v5, 3, v4
  s_lshl_b32 s28, s20, 6
  s_add_u32 s28, s28, 155648
  v_add_u32 v228, s28, v4
  s_mul_i32 s28, s20, 3072
  s_add_u32 s28, s28, 122880
  v_lshl_add_u32 v226, v1, 2, s28
  v_lshlrev_b32 v7, 2, v1
  v_add_u32 v227, 135168, v7
  s_waitcnt vmcnt(8)
  v_bfe_u32 v4, v1, 4, 1
  v_mul_u32_u24 v4, 1280, v4
  v_and_b32 v5, 15, v1
  v_lshl_add_u32 v4, v5, 2, v4
  v_mul_u32_u24 v5, 160, v3
  s_mul_i32 s28, s20, 3072
  s_add_u32 s28, s28, 122880
  v_add3_u32 v4, v4, v5, s28
  ds_read_b32 v16, v4 offset:0
  ds_read_b32 v17, v4 offset:40
  ds_read_b32 v18, v4 offset:80
  ds_read_b32 v19, v4 offset:120
  ds_read_b32 v20, v4 offset:320
  ds_read_b32 v21, v4 offset:360
  ds_read_b32 v22, v4 offset:400
  ds_read_b32 v23, v4 offset:440
  ds_read_b32 v24, v4 offset:640
  ds_read_b32 v25, v4 offset:680
  ds_read_b32 v26, v4 offset:720
  ds_read_b32 v27, v4 offset:760
  ds_read_b32 v28, v4 offset:960
  ds_read_b32 v29, v4 offset:1000
  ds_read_b32 v30, v4 offset:1040
  ds_read_b32 v31, v4 offset:1080
  s_waitcnt lgkmcnt(0)
  v_mfma_f32_32x32x16_bf16 v[32:47], v[16:19], a[216:219], 0
  v_mfma_f32_32x32x16_bf16 v[48:63], v[16:19], a[232:235], 0
  v_mfma_f32_32x32x16_bf16 v[32:47], v[20:23], a[220:223], v[32:47]
  v_mfma_f32_32x32x16_bf16 v[48:63], v[20:23], a[236:239], v[48:63]
  v_mfma_f32_32x32x16_bf16 v[32:47], v[24:27], a[224:227], v[32:47]
  v_mfma_f32_32x32x16_bf16 v[48:63], v[24:27], a[240:243], v[48:63]
  v_mfma_f32_32x32x16_bf16 v[32:47], v[28:31], a[228:231], v[32:47]
  v_mfma_f32_32x32x16_bf16 v[48:63], v[28:31], a[244:247], v[48:63]
  v_mov_b32 v102, 0
  v_mov_b32 v103, 0
  v_mov_b32 v110, 0
  v_mov_b32 v111, 0
  s_nop 7
  v_pk_mul_f32 v[4:5], v[48:49], v[198:199]
  v_pk_mul_f32 v[6:7], v[48:49], v[192:193]
  v_pk_fma_f32 v[4:5], v[32:33], v[192:193], v[4:5] neg_lo:[0,0,1] neg_hi:[0,0,1]
  v_pk_fma_f32 v[6:7], v[32:33], v[198:199], v[6:7]
  v_cvt_pk_bf16_f32 v96, v4, v6
  v_cvt_pk_bf16_f32 v97, v5, v7
  v_pk_mul_f32 v[4:5], v[50:51], v[200:201]
  v_pk_mul_f32 v[6:7], v[50:51], v[194:195]
  v_pk_fma_f32 v[4:5], v[34:35], v[194:195], v[4:5] neg_lo:[0,0,1] neg_hi:[0,0,1]
  v_pk_fma_f32 v[6:7], v[34:35], v[200:201], v[6:7]
  v_cvt_pk_bf16_f32 v98, v4, v6
  v_cvt_pk_bf16_f32 v99, v5, v7
  v_pk_mul_f32 v[4:5], v[52:53], v[202:203]
  v_pk_mul_f32 v[6:7], v[52:53], v[196:197]
  v_pk_fma_f32 v[4:5], v[36:37], v[196:197], v[4:5] neg_lo:[0,0,1] neg_hi:[0,0,1]
  v_pk_fma_f32 v[6:7], v[36:37], v[202:203], v[6:7]
  v_cvt_pk_bf16_f32 v100, v4, v6
  v_cvt_pk_bf16_f32 v101, v5, v7
  v_pk_mul_f32 v[4:5], v[56:57], v[198:199]
  v_pk_mul_f32 v[6:7], v[56:57], v[192:193]
  v_pk_fma_f32 v[4:5], v[40:41], v[192:193], v[4:5] neg_lo:[0,0,1] neg_hi:[0,0,1]
  v_pk_fma_f32 v[6:7], v[40:41], v[198:199], v[6:7]
  v_cvt_pk_bf16_f32 v104, v4, v6
  v_cvt_pk_bf16_f32 v105, v5, v7
  v_pk_mul_f32 v[4:5], v[58:59], v[200:201]
  v_pk_mul_f32 v[6:7], v[58:59], v[194:195]
  v_pk_fma_f32 v[4:5], v[42:43], v[194:195], v[4:5] neg_lo:[0,0,1] neg_hi:[0,0,1]
  v_pk_fma_f32 v[6:7], v[42:43], v[200:201], v[6:7]
  v_cvt_pk_bf16_f32 v106, v4, v6
  v_cvt_pk_bf16_f32 v107, v5, v7
  v_pk_mul_f32 v[4:5], v[60:61], v[202:203]
  v_pk_mul_f32 v[6:7], v[60:61], v[196:197]
  v_pk_fma_f32 v[4:5], v[44:45], v[196:197], v[4:5] neg_lo:[0,0,1] neg_hi:[0,0,1]
  v_pk_fma_f32 v[6:7], v[44:45], v[202:203], v[6:7]
  v_cvt_pk_bf16_f32 v108, v4, v6
  v_cvt_pk_bf16_f32 v109, v5, v7
  v_mfma_f32_32x32x16_bf16 v[32:47], a[248:251], v[96:99], 0
  v_mfma_f32_32x32x16_bf16 v[32:47], a[252:255], v[100:103], v[32:47]
  v_mfma_f32_32x32x16_bf16 v[48:63], a[248:251], v[104:107], 0
  v_mfma_f32_32x32x16_bf16 v[48:63], a[252:255], v[108:111], v[48:63]
  s_mul_i32 s28, s20, 5184
  s_add_u32 s28, s28, 98304
  v_lshl_add_u32 v4, v3, 6, v2
  v_lshl_add_u32 v4, v4, 3, s28
  s_nop 5
  ds_write_b64 v4, v[32:33] offset:0
  ds_write_b64 v4, v[34:35] offset:256
  ds_write_b64 v4, v[48:49] offset:2560
  ds_write_b64 v4, v[50:51] offset:2816
  ds_write_b64 v4, v[36:37] offset:1024
  ds_write_b64 v4, v[38:39] offset:1280
  ds_write_b64 v4, v[52:53] offset:3584
  ds_write_b64 v4, v[54:55] offset:3840
  s_mov_b64 exec, 0xffffffff
  ds_write_b64 v4, v[40:41] offset:2048
  ds_write_b64 v4, v[42:43] offset:2304
  ds_write_b64 v4, v[56:57] offset:4608
  ds_write_b64 v4, v[58:59] offset:4864
  s_mov_b64 exec, -1
  s_waitcnt lgkmcnt(0)
  s_add_u32 s90, s90, 1
  s_waitcnt vmcnt(1)
  s_add_u32 m0, s23, 0
  s_mov_b32 s21, 0
  buffer_load_dwordx4 v230, s[8:11], s21 offen lds
  s_add_u32 m0, s23, 0
  s_mov_b32 s21, 0
  buffer_load_dwordx4 v231, s[8:11], s21 offen offset:1024 lds
  s_add_u32 m0, s23, 0
  s_mov_b32 s21, 0
  buffer_load_dwordx4 v232, s[8:11], s21 offen offset:2048 lds
  s_add_u32 m0, s23, 0
  s_mov_b32 s21, 0
  buffer_load_dwordx4 v233, s[8:11], s21 offen offset:3072 lds
  s_add_u32 m0, s24, 0
  s_mov_b32 s22, 0
  buffer_load_dwordx4 v234, s[12:15], s22 offen lds
  s_add_u32 m0, s24, 0
  s_mov_b32 s22, 0
  buffer_load_dwordx4 v235, s[12:15], s22 offen offset:1024 lds
  s_add_u32 m0, s24, 0
  s_mov_b32 s22, 0
  buffer_load_dwordx4 v236, s[12:15], s22 offen offset:2048 lds
  s_waitcnt lgkmcnt(0)
  s_barrier
  ds_read_b64 v[16:17], v112 offset:0
  ds_read_b64 v[18:19], v113 offset:0
  ds_read_b64 v[20:21], v112 offset:2560
  ds_read_b64 v[22:23], v113 offset:2560
  ds_read_b64 v[24:25], v112 offset:512
  ds_read_b64 v[26:27], v114 offset:512
  ds_read_b64 v[28:29], v112 offset:3072
  ds_read_b64 v[30:31], v114 offset:3072
  ds_read_b64 v[32:33], v112 offset:1024
  ds_read_b64 v[34:35], v114 offset:0
  ds_read_b64 v[36:37], v112 offset:3584
  ds_read_b64 v[38:39], v114 offset:2560
  s_waitcnt lgkmcnt(8)
  v_pk_add_f32 v[40:41], v[16:17], v[20:21]
  v_pk_add_f32 v[44:45], v[16:17], v[20:21] neg_lo:[0,1] neg_hi:[0,1]
  v_pk_add_f32 v[42:43], v[18:19], v[22:23]
  v_pk_add_f32 v[46:47], v[18:19], v[22:23] neg_lo:[0,1] neg_hi:[0,1]
  v_pk_add_f32 v[48:49], v[40:41], v[42:43] neg_hi:[0,1]
  v_pk_add_f32 v[52:53], v[40:41], v[42:43] neg_lo:[0,1]
  v_pk_add_f32 v[50:51], v[44:45], v[46:47] neg_hi:[0,1]
  v_pk_add_f32 v[54:55], v[44:45], v[46:47] neg_lo:[0,1]
  v_pk_mul_f32 v[56:57], v[52:53], v[118:119] op_sel:[1,1] op_sel_hi:[1,0]
  v_pk_mul_f32 v[58:59], v[54:55], v[118:119] op_sel:[1,1] op_sel_hi:[1,0]
  v_pk_fma_f32 v[56:57], v[52:53], v[118:119], v[56:57] op_sel:[0,0,0] op_sel_hi:[0,1,1] neg_lo:[0,0,1]
  v_pk_fma_f32 v[58:59], v[54:55], v[118:119], v[58:59] op_sel:[0,0,0] op_sel_hi:[0,1,1] neg_lo:[0,0,1]
  v_pk_add_f32 v[60:61], v[48:49], v[56:57]
  v_pk_add_f32 v[62:63], v[48:49], v[56:57] neg_lo:[0,1] neg_hi:[1,0]
  v_pk_add_f32 v[64:65], v[50:51], v[58:59]
  v_pk_add_f32 v[66:67], v[50:51], v[58:59] neg_lo:[0,1] neg_hi:[1,0]
  v_pk_mul_f32 v[48:49], v[64:65], v[124:125] op_sel:[1,1] op_sel_hi:[1,0]
  v_pk_mul_f32 v[50:51], v[66:67], v[124:125] op_sel:[1,1] op_sel_hi:[1,0]
  v_pk_fma_f32 v[64:65], v[64:65], v[124:125], v[48:49] op_sel:[0,0,0] op_sel_hi:[0,1,1] neg_lo:[0,0,1]
  v_pk_fma_f32 v[66:67], v[66:67], v[124:125], v[50:51] op_sel:[0,0,0] op_sel_hi:[0,1,1] neg_lo:[0,0,1]
  v_cvt_pk_bf16_f32 v68, v60, v61
  v_cvt_pk_bf16_f32 v69, v62, v63
  v_cvt_pk_bf16_f32 v70, v64, v65
  v_cvt_pk_bf16_f32 v71, v66, v67
  s_mov_b32 s28, 0
  buffer_store_dwordx2 v[68:69], v115, s[36:39], s28 offen sc1
  s_mov_b32 s29, 16384
  buffer_store_dwordx2 v[70:71], v115, s[36:39], s29 offen sc1
  s_waitcnt lgkmcnt(4)
  v_pk_add_f32 v[40:41], v[24:25], v[28:29]
  v_pk_add_f32 v[44:45], v[24:25], v[28:29] neg_lo:[0,1] neg_hi:[0,1]
  v_pk_add_f32 v[42:43], v[26:27], v[30:31]
  v_pk_add_f32 v[46:47], v[26:27], v[30:31] neg_lo:[0,1] neg_hi:[0,1]
  v_pk_add_f32 v[48:49], v[40:41], v[42:43] neg_hi:[0,1]
  v_pk_add_f32 v[52:53], v[40:41], v[42:43] neg_lo:[0,1]
  v_pk_add_f32 v[50:51], v[44:45], v[46:47] neg_hi:[0,1]
  v_pk_add_f32 v[54:55], v[44:45], v[46:47] neg_lo:[0,1]
  v_pk_mul_f32 v[56:57], v[52:53], v[120:121] op_sel:[1,1] op_sel_hi:[1,0]
  v_pk_mul_f32 v[58:59], v[54:55], v[120:121] op_sel:[1,1] op_sel_hi:[1,0]
  v_pk_fma_f32 v[56:57], v[52:53], v[120:121], v[56:57] op_sel:[0,0,0] op_sel_hi:[0,1,1] neg_lo:[0,0,1]
  v_pk_fma_f32 v[58:59], v[54:55], v[120:121], v[58:59] op_sel:[0,0,0] op_sel_hi:[0,1,1] neg_lo:[0,0,1]
  v_pk_add_f32 v[60:61], v[48:49], v[56:57]
  v_pk_add_f32 v[62:63], v[48:49], v[56:57] neg_lo:[0,1] neg_hi:[1,0]
  v_pk_add_f32 v[64:65], v[50:51], v[58:59]
  v_pk_add_f32 v[66:67], v[50:51], v[58:59] neg_lo:[0,1] neg_hi:[1,0]
  v_pk_mul_f32 v[48:49], v[64:65], v[124:125] op_sel:[1,1] op_sel_hi:[1,0]
  v_pk_mul_f32 v[50:51], v[66:67], v[124:125] op_sel:[1,1] op_sel_hi:[1,0]
  v_pk_fma_f32 v[64:65], v[64:65], v[124:125], v[48:49] op_sel:[0,0,0] op_sel_hi:[0,1,1] neg_lo:[0,0,1]
  v_pk_fma_f32 v[66:67], v[66:67], v[124:125], v[50:51] op_sel:[0,0,0] op_sel_hi:[0,1,1] neg_lo:[0,0,1]
  v_cvt_pk_bf16_f32 v72, v60, v61
  v_cvt_pk_bf16_f32 v73, v62, v63
  v_cvt_pk_bf16_f32 v74, v64, v65
  v_cvt_pk_bf16_f32 v75, v66, v67
  s_mov_b32 s28, 1048576
  buffer_store_dwordx2 v[72:73], v115, s[36:39], s28 offen sc1
  s_mov_b32 s29, 1064960
  buffer_store_dwordx2 v[74:75], v115, s[36:39], s29 offen sc1
  s_waitcnt lgkmcnt(0)
  v_pk_add_f32 v[40:41], v[32:33], v[36:37]
  v_pk_add_f32 v[44:45], v[32:33], v[36:37] neg_lo:[0,1] neg_hi:[0,1]
  v_pk_add_f32 v[42:43], v[34:35], v[38:39]
  v_pk_add_f32 v[46:47], v[34:35], v[38:39] neg_lo:[0,1] neg_hi:[0,1]
  v_pk_add_f32 v[48:49], v[40:41], v[42:43] neg_hi:[0,1]
  v_pk_add_f32 v[52:53], v[40:41], v[42:43] neg_lo:[0,1]
  v_pk_add_f32 v[50:51], v[44:45], v[46:47] neg_hi:[0,1]
  v_pk_add_f32 v[54:55], v[44:45], v[46:47] neg_lo:[0,1]
  v_pk_mul_f32 v[56:57], v[52:53], v[122:123] op_sel:[1,1] op_sel_hi:[1,0]
  v_pk_mul_f32 v[58:59], v[54:55], v[122:123] op_sel:[1,1] op_sel_hi:[1,0]
  v_pk_fma_f32 v[56:57], v[52:53], v[122:123], v[56:57] op_sel:[0,0,0] op_sel_hi:[0,1,1] neg_lo:[0,0,1]
  v_pk_fma_f32 v[58:59], v[54:55], v[122:123], v[58:59] op_sel:[0,0,0] op_sel_hi:[0,1,1] neg_lo:[0,0,1]
  v_pk_add_f32 v[60:61], v[48:49], v[56:57]
  v_pk_add_f32 v[62:63], v[48:49], v[56:57] neg_lo:[0,1] neg_hi:[1,0]
  v_pk_add_f32 v[64:65], v[50:51], v[58:59]
  v_pk_add_f32 v[66:67], v[50:51], v[58:59] neg_lo:[0,1] neg_hi:[1,0]
  v_pk_mul_f32 v[48:49], v[64:65], v[124:125] op_sel:[1,1] op_sel_hi:[1,0]
  v_pk_mul_f32 v[50:51], v[66:67], v[124:125] op_sel:[1,1] op_sel_hi:[1,0]
  v_pk_fma_f32 v[64:65], v[64:65], v[124:125], v[48:49] op_sel:[0,0,0] op_sel_hi:[0,1,1] neg_lo:[0,0,1]
  v_pk_fma_f32 v[66:67], v[66:67], v[124:125], v[50:51] op_sel:[0,0,0] op_sel_hi:[0,1,1] neg_lo:[0,0,1]
  v_cvt_pk_bf16_f32 v76, v60, v61
  v_cvt_pk_bf16_f32 v77, v62, v63
  v_cvt_pk_bf16_f32 v78, v64, v65
  v_cvt_pk_bf16_f32 v79, v66, v67
  v_lshrrev_b32 v7, 2, v0
  v_cmp_eq_u32 vcc, 33, v7
  s_nop 1
  v_cndmask_b32_e64 v76, v76, 0, vcc
  v_cndmask_b32_e64 v77, v77, 0, vcc
  v_cndmask_b32_e64 v78, v78, 0, vcc
  v_cndmask_b32_e64 v79, v79, 0, vcc
  s_mov_b32 s28, 2097152
  buffer_store_dwordx2 v[76:77], v116, s[36:39], s28 offen sc1
  s_mov_b32 s29, 2113536
  buffer_store_dwordx2 v[78:79], v116, s[36:39], s29 offen sc1
  ds_read_u16 v16, v126 offset:0
  ds_read_u16 v20, v126 offset:6208
  ds_read_u16 v17, v127 offset:384
  ds_read_u16 v21, v127 offset:6592
  ds_read_u16 v18, v128 offset:768
  ds_read_u16 v22, v128 offset:6976
  ds_read_u16 v19, v129 offset:1152
  ds_read_u16 v23, v129 offset:7360
  ds_read_u16 v24, v126 offset:64
  ds_read_u16 v28, v126 offset:6272
  ds_read_u16 v25, v127 offset:448
  ds_read_u16 v29, v127 offset:6656
  ds_read_u16 v26, v128 offset:832
  ds_read_u16 v30, v128 offset:7040
  ds_read_u16 v27, v129 offset:1216
  ds_read_u16 v31, v129 offset:7424
  ds_read_u16 v32, v126 offset:128
  ds_read_u16 v36, v126 offset:6336
  ds_read_u16 v33, v127 offset:512
  ds_read_u16 v37, v127 offset:6720
  ds_read_u16 v34, v128 offset:896
  ds_read_u16 v38, v128 offset:7104
  ds_read_u16 v35, v129 offset:1280
  ds_read_u16 v39, v129 offset:7488
  s_waitcnt lgkmcnt(15)
  v_lshl_or_b32 v16, v20, 16, v16
  v_lshl_or_b32 v17, v21, 16, v17
  v_lshl_or_b32 v18, v22, 16, v18
  v_lshl_or_b32 v19, v23, 16, v19
  buffer_store_dwordx4 v[16:19], v130, s[48:51], 0 offen sc1
  s_waitcnt lgkmcnt(8)
  v_lshl_or_b32 v24, v28, 16, v24
  v_lshl_or_b32 v25, v29, 16, v25
  v_lshl_or_b32 v26, v30, 16, v26
  v_lshl_or_b32 v27, v31, 16, v27
  buffer_store_dwordx4 v[24:27], v131, s[48:51], 0 offen sc1
  s_waitcnt lgkmcnt(0)
  v_lshl_or_b32 v32, v36, 16, v32
  v_lshl_or_b32 v33, v37, 16, v33
  v_lshl_or_b32 v34, v38, 16, v34
  v_lshl_or_b32 v35, v39, 16, v35
  buffer_store_dwordx4 v[32:35], v132, s[48:51], 0 offen sc1
  buffer_store_dwordx4 v[32:35], v133, s[48:51], 0 offen sc1
  s_add_u32 m0, s24, 12288
  s_mov_b32 s22, 98304
  buffer_load_dwordx4 v234, s[12:15], s22 offen lds
  s_add_u32 m0, s24, 12288
  s_mov_b32 s22, 98304
  buffer_load_dwordx4 v235, s[12:15], s22 offen offset:1024 lds
  s_add_u32 m0, s24, 12288
  s_mov_b32 s22, 98304
  buffer_load_dwordx4 v236, s[12:15], s22 offen offset:2048 lds
  s_mul_i32 s30, s98, 52429
  s_lshr_b32 s30, s30, 18
  s_mul_i32 s31, s30, 5
  s_sub_u32 s31, s98, s31
  ds_read_b64_tr_b16 v[40:41], v228 offset:0
  ds_read_b64_tr_b16 v[42:43], v228 offset:2048
  ds_read_b64_tr_b16 v[44:45], v228 offset:32
  ds_read_b64_tr_b16 v[46:47], v228 offset:2080
  s_mul_i32 s30, s30, 40
  s_lshl_b32 s31, s31, 3
  s_add_u32 s30, s30, s31
  s_lshl_b32 s31, s20, 1
  s_add_u32 s30, s30, s31
  s_lshl_b32 s30, s30, 10
  v_lshlrev_b32 v5, 4, v1
  s_waitcnt lgkmcnt(0)
  buffer_store_dwordx4 v[40:43], v5, s[56:59], s30 offen sc1
  buffer_store_dwordx4 v[44:47], v5, s[56:59], s30 offen offset:1024 sc1
  s_add_u32 m0, s23, 16384
  s_mov_b32 s21, 128
  buffer_load_dwordx4 v230, s[8:11], s21 offen lds
  s_add_u32 m0, s23, 16384
  s_mov_b32 s21, 128
  buffer_load_dwordx4 v231, s[8:11], s21 offen offset:1024 lds
  s_add_u32 m0, s23, 16384
  s_mov_b32 s21, 128
  buffer_load_dwordx4 v232, s[8:11], s21 offen offset:2048 lds
  s_add_u32 m0, s23, 16384
  s_mov_b32 s21, 128
  buffer_load_dwordx4 v233, s[8:11], s21 offen offset:3072 lds
  s_add_u32 m0, s24, 24576
  s_mov_b32 s22, 196608
  buffer_load_dwordx4 v234, s[12:15], s22 offen lds
  s_add_u32 m0, s24, 24576
  s_mov_b32 s22, 196608
  buffer_load_dwordx4 v235, s[12:15], s22 offen offset:1024 lds
  s_add_u32 m0, s24, 24576
  s_mov_b32 s22, 196608
  buffer_load_dwordx4 v236, s[12:15], s22 offen offset:2048 lds
  s_add_u32 m0, s24, 36864
  s_mov_b32 s22, 294912
  buffer_load_dwordx4 v234, s[12:15], s22 offen lds
  s_add_u32 m0, s24, 36864
  s_mov_b32 s22, 294912
  buffer_load_dwordx4 v235, s[12:15], s22 offen offset:1024 lds
  s_add_u32 m0, s24, 36864
  s_mov_b32 s22, 294912
  buffer_load_dwordx4 v236, s[12:15], s22 offen offset:2048 lds
  s_add_u32 m0, s23, 32768
  s_mov_b32 s21, 256
  buffer_load_dwordx4 v230, s[8:11], s21 offen lds
  s_add_u32 m0, s23, 32768
  s_mov_b32 s21, 256
  buffer_load_dwordx4 v231, s[8:11], s21 offen offset:1024 lds
  s_add_u32 m0, s23, 32768
  s_mov_b32 s21, 256
  buffer_load_dwordx4 v232, s[8:11], s21 offen offset:2048 lds
  s_add_u32 m0, s23, 32768
  s_mov_b32 s21, 256
  buffer_load_dwordx4 v233, s[8:11], s21 offen offset:3072 lds
  ds_read_b32 v204, v226 offset:0
  ds_read_b32 v209, v226 offset:1280
  ds_read_b32 v214, v227 offset:0
  ds_read_b32 v205, v226 offset:256
  ds_read_b32 v210, v226 offset:1536
  ds_read_b32 v215, v227 offset:256
  ds_read_b32 v206, v226 offset:512
  ds_read_b32 v211, v226 offset:1792
  ds_read_b32 v216, v227 offset:512
  ds_read_b32 v207, v226 offset:768
  ds_read_b32 v212, v226 offset:2048
  ds_read_b32 v217, v227 offset:768
  ds_read_b32 v208, v226 offset:1024
  ds_read_b32 v213, v226 offset:2304
  ds_read_b32 v218, v227 offset:1024
  s_waitcnt lgkmcnt(0)
  v_mov_b32 v4, 0
  v_dot2c_f32_bf16 v4, v204, v214
  v_dot2c_f32_bf16 v4, v205, v215
  v_dot2c_f32_bf16 v4, v206, v216
  v_dot2c_f32_bf16 v4, v207, v217
  v_dot2c_f32_bf16 v4, v208, v218
  v_mov_b32 v5, 0
  v_dot2c_f32_bf16 v5, v209, v214
  v_dot2c_f32_bf16 v5, v210, v215
  v_dot2c_f32_bf16 v5, v211, v216
  v_dot2c_f32_bf16 v5, v212, v217
  v_dot2c_f32_bf16 v5, v213, v218
  v_add_f32_dpp v4, v4, v4 quad_perm:[1,0,3,2] row_mask:0xf bank_mask:0xf
  s_nop 1
  v_add_f32_dpp v5, v5, v5 quad_perm:[1,0,3,2] row_mask:0xf bank_mask:0xf
  v_add_f32_dpp v4, v4, v4 quad_perm:[2,3,0,1] row_mask:0xf bank_mask:0xf
  s_nop 0
  v_add_f32_dpp v5, v5, v5 quad_perm:[2,3,0,1] row_mask:0xf bank_mask:0xf
  v_add_f32_dpp v4, v4, v4 row_half_mirror row_mask:0xf bank_mask:0xf
  s_nop 0
  v_add_f32_dpp v5, v5, v5 row_half_mirror row_mask:0xf bank_mask:0xf
  v_add_f32_dpp v4, v4, v4 row_mirror row_mask:0xf bank_mask:0xf
  s_nop 0
  v_add_f32_dpp v5, v5, v5 row_mirror row_mask:0xf bank_mask:0xf
  v_readlane_b32 s16, v4, 0
  v_readlane_b32 s17, v4, 16
  v_readlane_b32 s18, v4, 32
  v_readlane_b32 s19, v4, 48
  v_mov_b32 v4, s16
  v_add_f32 v4, s17, v4
  v_add_f32 v4, s18, v4
  v_add_f32 v4, s19, v4
  v_readlane_b32 s16, v5, 0
  v_readlane_b32 s17, v5, 16
  v_readlane_b32 s18, v5, 32
  v_readlane_b32 s19, v5, 48
  v_mov_b32 v5, s16
  v_add_f32 v5, s17, v5
  v_add_f32 v5, s18, v5
  v_add_f32 v5, s19, v5
  v_and_b32 v6, 1, v1
  v_cmp_eq_u32 vcc, 1, v6
  s_nop 1
  v_cndmask_b32 v4, v4, v5, vcc
  v_cvt_pk_bf16_f32 v4, v4, v4
  v_and_b32 v4, 0xffff0000, v4
  v_mul_f32 v4, 0xbfb8aa3b, v4
  v_exp_f32 v4, v4
  s_nop 0
  v_add_f32 v4, 1.0, v4
  v_rcp_f32 v4, v4
  s_nop 0
  v_cvt_pk_bf16_f32 v4, v4, v4
  v_and_b32 v4, 0xffff0000, v4
  s_nop 0
  v_readlane_b32 s27, v4, 0
  v_readlane_b32 s91, v4, 1
  s_lshl_b32 s28, s3, 2
  s_add_u32 s28, s28, s20
  s_lshl_b32 s28, s28, 2
  v_lshlrev_b32 v6, 12, v6
  v_add_u32 v6, s28, v6
  v_mov_b32 v7, 0x40000000
  v_cmp_gt_u32 vcc, 2, v1
  s_nop 1
  v_cndmask_b32 v6, v7, v6, vcc
  buffer_store_dword v4, v6, s[64:67], 0 offen sc1
  s_waitcnt vmcnt(15)
  s_barrier
  s_lshl_b32 s97, s98, 2
  s_add_u32 s97, s97, 32768
  s_cmp_eq_u32 s20, 0
  s_cselect_b32 s97, s97, 0x40000000
  v_mov_b32 v249, s90
  v_and_b32 v254, 7, v0
  v_lshlrev_b32 v254, 10, v254
  s_mov_b64 exec, 0xff
  buffer_store_dword v249, v254, s[92:95], s97 offen sc1
  s_mov_b64 exec, -1
  ds_read_b64_tr_b16 v[16:17], v241 offset:0
  ds_read_b64_tr_b16 v[18:19], v241 offset:768
  ds_read_b128 v[28:31], v237 offset:0
  ds_read_b128 v[32:35], v237 offset:4096
  ds_read_b64_tr_b16 v[20:21], v241 offset:32
  ds_read_b64_tr_b16 v[22:23], v241 offset:800
  ds_read_b64_tr_b16 v[24:25], v242 offset:64
  ds_read_b64_tr_b16 v[26:27], v242 offset:832
  s_waitcnt lgkmcnt(0)
  v_mfma_f32_32x32x16_bf16 v[64:79], v[16:19], v[28:31], 0
  ds_read_b64_tr_b16 v[36:37], v241 offset:3072
  ds_read_b64_tr_b16 v[38:39], v241 offset:3840
  ds_read_b128 v[48:51], v238 offset:0
  s_add_u32 m0, s24, 49152
  s_mov_b32 s22, 393216
  buffer_load_dwordx4 v234, s[12:15], s22 offen lds
  v_mfma_f32_32x32x16_bf16 v[80:95], v[16:19], v[32:35], 0
  ds_read_b128 v[52:55], v238 offset:4096
  ds_read_b64_tr_b16 v[40:41], v241 offset:3104
  ds_read_b64_tr_b16 v[42:43], v241 offset:3872
  s_add_u32 m0, s24, 49152
  s_mov_b32 s22, 393216
  buffer_load_dwordx4 v235, s[12:15], s22 offen offset:1024 lds
  v_mfma_f32_32x32x16_bf16 v[96:111], v[20:23], v[28:31], 0
  ds_read_b64_tr_b16 v[44:45], v242 offset:3136
  ds_read_b64_tr_b16 v[46:47], v242 offset:3904
  s_add_u32 m0, s24, 49152
  s_mov_b32 s22, 393216
  buffer_load_dwordx4 v236, s[12:15], s22 offen offset:2048 lds
  v_mfma_f32_32x32x16_bf16 v[112:127], v[20:23], v[32:35], 0
  s_add_u32 m0, s24, 61440
  s_mov_b32 s22, 491520
  buffer_load_dwordx4 v234, s[12:15], s22 offen lds
  v_mfma_f32_32x32x16_bf16 v[128:143], v[24:27], v[28:31], 0
  s_add_u32 m0, s24, 61440
  s_mov_b32 s22, 491520
  buffer_load_dwordx4 v235, s[12:15], s22 offen offset:1024 lds
  v_mfma_f32_32x32x16_bf16 v[144:159], v[24:27], v[32:35], 0
  s_add_u32 m0, s24, 61440
  s_mov_b32 s22, 491520
  buffer_load_dwordx4 v236, s[12:15], s22 offen offset:2048 lds
  s_waitcnt vmcnt(22) lgkmcnt(0)
  s_barrier
  v_mfma_f32_32x32x16_bf16 v[64:79], v[36:39], v[48:51], v[64:79]
  ds_read_b64_tr_b16 v[16:17], v241 offset:12288
  ds_read_b64_tr_b16 v[18:19], v241 offset:13056
  ds_read_b128 v[28:31], v239 offset:0
  s_mov_b32 s63, s98
  v_mfma_f32_32x32x16_bf16 v[80:95], v[36:39], v[52:55], v[80:95]
  ds_read_b128 v[32:35], v239 offset:4096
  ds_read_b64_tr_b16 v[20:21], v241 offset:12320
  ds_read_b64_tr_b16 v[22:23], v241 offset:13088
  v_mfma_f32_32x32x16_bf16 v[96:111], v[40:43], v[48:51], v[96:111]
  ds_read_b64_tr_b16 v[24:25], v242 offset:12352
  ds_read_b64_tr_b16 v[26:27], v242 offset:13120
  v_mfma_f32_32x32x16_bf16 v[112:127], v[40:43], v[52:55], v[112:127]
  v_mfma_f32_32x32x16_bf16 v[128:143], v[44:47], v[48:51], v[128:143]
  s_add_u32 m0, s24, 0
  s_mov_b32 s22, 589824
  buffer_load_dwordx4 v234, s[12:15], s22 offen lds
  v_mfma_f32_32x32x16_bf16 v[144:159], v[44:47], v[52:55], v[144:159]
  s_add_u32 m0, s24, 0
  s_mov_b32 s22, 589824
  buffer_load_dwordx4 v235, s[12:15], s22 offen offset:1024 lds
  s_waitcnt lgkmcnt(0)
  v_mfma_f32_32x32x16_bf16 v[64:79], v[16:19], v[28:31], v[64:79]
  ds_read_b64_tr_b16 v[36:37], v241 offset:15360
  ds_read_b64_tr_b16 v[38:39], v241 offset:16128
  ds_read_b128 v[48:51], v240 offset:0
  v_mfma_f32_32x32x16_bf16 v[80:95], v[16:19], v[32:35], v[80:95]
  ds_read_b128 v[52:55], v240 offset:4096
  ds_read_b64_tr_b16 v[40:41], v241 offset:15392
  ds_read_b64_tr_b16 v[42:43], v241 offset:16160
  s_add_u32 m0, s24, 0
  s_mov_b32 s22, 589824
  buffer_load_dwordx4 v236, s[12:15], s22 offen offset:2048 lds
  v_mfma_f32_32x32x16_bf16 v[96:111], v[20:23], v[28:31], v[96:111]
  ds_read_b64_tr_b16 v[44:45], v242 offset:15424
  ds_read_b64_tr_b16 v[46:47], v242 offset:16192
  v_mfma_f32_32x32x16_bf16 v[112:127], v[20:23], v[32:35], v[112:127]
  v_mfma_f32_32x32x16_bf16 v[128:143], v[24:27], v[28:31], v[128:143]
  v_mfma_f32_32x32x16_bf16 v[144:159], v[24:27], v[32:35], v[144:159]
  s_waitcnt vmcnt(18) lgkmcnt(0)
  s_barrier
  v_mfma_f32_32x32x16_bf16 v[64:79], v[36:39], v[48:51], v[64:79]
  ds_read_b64_tr_b16 v[16:17], v241 offset:24576
  ds_read_b64_tr_b16 v[18:19], v241 offset:25344
  ds_read_b128 v[28:31], v237 offset:16384
  s_add_u32 m0, s23, 0
  s_mov_b32 s21, 384
  buffer_load_dwordx4 v230, s[8:11], s21 offen lds
  v_mfma_f32_32x32x16_bf16 v[80:95], v[36:39], v[52:55], v[80:95]
  ds_read_b128 v[32:35], v237 offset:20480
  ds_read_b64_tr_b16 v[20:21], v241 offset:24608
  ds_read_b64_tr_b16 v[22:23], v241 offset:25376
  s_add_u32 m0, s23, 0
  s_mov_b32 s21, 384
  buffer_load_dwordx4 v231, s[8:11], s21 offen offset:1024 lds
  v_mfma_f32_32x32x16_bf16 v[96:111], v[40:43], v[48:51], v[96:111]
  ds_read_b64_tr_b16 v[24:25], v242 offset:24640
  ds_read_b64_tr_b16 v[26:27], v242 offset:25408
  s_add_u32 m0, s23, 0
  s_mov_b32 s21, 384
  buffer_load_dwordx4 v232, s[8:11], s21 offen offset:2048 lds
  v_mfma_f32_32x32x16_bf16 v[112:127], v[40:43], v[52:55], v[112:127]
  s_add_u32 m0, s23, 0
  s_mov_b32 s21, 384
  buffer_load_dwordx4 v233, s[8:11], s21 offen offset:3072 lds
  v_mfma_f32_32x32x16_bf16 v[128:143], v[44:47], v[48:51], v[128:143]
  s_add_u32 m0, s24, 12288
  s_mov_b32 s22, 688128
  buffer_load_dwordx4 v234, s[12:15], s22 offen lds
  v_mfma_f32_32x32x16_bf16 v[144:159], v[44:47], v[52:55], v[144:159]
  s_add_u32 m0, s24, 12288
  s_mov_b32 s22, 688128
  buffer_load_dwordx4 v235, s[12:15], s22 offen offset:1024 lds
  s_waitcnt lgkmcnt(0)
  v_mfma_f32_32x32x16_bf16 v[64:79], v[16:19], v[28:31], v[64:79]
  ds_read_b64_tr_b16 v[36:37], v241 offset:27648
  ds_read_b64_tr_b16 v[38:39], v241 offset:28416
  ds_read_b128 v[48:51], v238 offset:16384
  v_mfma_f32_32x32x16_bf16 v[80:95], v[16:19], v[32:35], v[80:95]
  ds_read_b128 v[52:55], v238 offset:20480
  ds_read_b64_tr_b16 v[40:41], v241 offset:27680
  ds_read_b64_tr_b16 v[42:43], v241 offset:28448
  s_add_u32 m0, s24, 12288
  s_mov_b32 s22, 688128
  buffer_load_dwordx4 v236, s[12:15], s22 offen offset:2048 lds
  v_mfma_f32_32x32x16_bf16 v[96:111], v[20:23], v[28:31], v[96:111]
  ds_read_b64_tr_b16 v[44:45], v242 offset:27712
  ds_read_b64_tr_b16 v[46:47], v242 offset:28480
  v_mfma_f32_32x32x16_bf16 v[112:127], v[20:23], v[32:35], v[112:127]
  v_mfma_f32_32x32x16_bf16 v[128:143], v[24:27], v[28:31], v[128:143]
  v_mfma_f32_32x32x16_bf16 v[144:159], v[24:27], v[32:35], v[144:159]
  s_waitcnt vmcnt(22) lgkmcnt(0)
  s_barrier
  v_mfma_f32_32x32x16_bf16 v[64:79], v[36:39], v[48:51], v[64:79]
  ds_read_b64_tr_b16 v[16:17], v241 offset:36864
  ds_read_b64_tr_b16 v[18:19], v241 offset:37632
  ds_read_b128 v[28:31], v239 offset:16384
  v_mfma_f32_32x32x16_bf16 v[80:95], v[36:39], v[52:55], v[80:95]
  ds_read_b128 v[32:35], v239 offset:20480
  ds_read_b64_tr_b16 v[20:21], v241 offset:36896
  ds_read_b64_tr_b16 v[22:23], v241 offset:37664
  s_add_u32 m0, s24, 24576
  s_mov_b32 s22, 786432
  buffer_load_dwordx4 v234, s[12:15], s22 offen lds
  v_mfma_f32_32x32x16_bf16 v[96:111], v[40:43], v[48:51], v[96:111]
  ds_read_b64_tr_b16 v[24:25], v242 offset:36928
  ds_read_b64_tr_b16 v[26:27], v242 offset:37696
  v_mfma_f32_32x32x16_bf16 v[112:127], v[40:43], v[52:55], v[112:127]
  s_add_u32 m0, s24, 24576
  s_mov_b32 s22, 786432
  buffer_load_dwordx4 v235, s[12:15], s22 offen offset:1024 lds
  v_mfma_f32_32x32x16_bf16 v[128:143], v[44:47], v[48:51], v[128:143]
  v_mfma_f32_32x32x16_bf16 v[144:159], v[44:47], v[52:55], v[144:159]
  s_add_u32 m0, s24, 24576
  s_mov_b32 s22, 786432
  buffer_load_dwordx4 v236, s[12:15], s22 offen offset:2048 lds
  s_waitcnt lgkmcnt(0)
  v_mfma_f32_32x32x16_bf16 v[64:79], v[16:19], v[28:31], v[64:79]
  ds_read_b64_tr_b16 v[36:37], v241 offset:39936
  ds_read_b64_tr_b16 v[38:39], v241 offset:40704
  ds_read_b128 v[48:51], v240 offset:16384
  v_mfma_f32_32x32x16_bf16 v[80:95], v[16:19], v[32:35], v[80:95]
  ds_read_b128 v[52:55], v240 offset:20480
  ds_read_b64_tr_b16 v[40:41], v241 offset:39968
  ds_read_b64_tr_b16 v[42:43], v241 offset:40736
  v_mfma_f32_32x32x16_bf16 v[96:111], v[20:23], v[28:31], v[96:111]
  ds_read_b64_tr_b16 v[44:45], v242 offset:40000
  ds_read_b64_tr_b16 v[46:47], v242 offset:40768
  v_mfma_f32_32x32x16_bf16 v[112:127], v[20:23], v[32:35], v[112:127]
  v_mfma_f32_32x32x16_bf16 v[128:143], v[24:27], v[28:31], v[128:143]
  v_mfma_f32_32x32x16_bf16 v[144:159], v[24:27], v[32:35], v[144:159]
  s_waitcnt vmcnt(16) lgkmcnt(0)
  s_barrier
  v_mfma_f32_32x32x16_bf16 v[64:79], v[36:39], v[48:51], v[64:79]
  ds_read_b64_tr_b16 v[16:17], v241 offset:49152
  ds_read_b64_tr_b16 v[18:19], v241 offset:49920
  ds_read_b128 v[28:31], v237 offset:32768
  s_add_u32 m0, s23, 16384
  s_mov_b32 s21, 512
  buffer_load_dwordx4 v230, s[8:11], s21 offen lds
  v_mfma_f32_32x32x16_bf16 v[80:95], v[36:39], v[52:55], v[80:95]
  ds_read_b128 v[32:35], v237 offset:36864
  ds_read_b64_tr_b16 v[20:21], v241 offset:49184
  ds_read_b64_tr_b16 v[22:23], v241 offset:49952
  s_add_u32 m0, s23, 16384
  s_mov_b32 s21, 512
  buffer_load_dwordx4 v231, s[8:11], s21 offen offset:1024 lds
  v_mfma_f32_32x32x16_bf16 v[96:111], v[40:43], v[48:51], v[96:111]
  ds_read_b64_tr_b16 v[24:25], v242 offset:49216
  ds_read_b64_tr_b16 v[26:27], v242 offset:49984
  s_add_u32 m0, s23, 16384
  s_mov_b32 s21, 512
  buffer_load_dwordx4 v232, s[8:11], s21 offen offset:2048 lds
  v_mfma_f32_32x32x16_bf16 v[112:127], v[40:43], v[52:55], v[112:127]
  s_add_u32 m0, s23, 16384
  s_mov_b32 s21, 512
  buffer_load_dwordx4 v233, s[8:11], s21 offen offset:3072 lds
  v_mfma_f32_32x32x16_bf16 v[128:143], v[44:47], v[48:51], v[128:143]
  s_add_u32 m0, s24, 36864
  s_mov_b32 s22, 884736
  buffer_load_dwordx4 v234, s[12:15], s22 offen lds
  v_mfma_f32_32x32x16_bf16 v[144:159], v[44:47], v[52:55], v[144:159]
  s_add_u32 m0, s24, 36864
  s_mov_b32 s22, 884736
  buffer_load_dwordx4 v235, s[12:15], s22 offen offset:1024 lds
  s_waitcnt lgkmcnt(0)
  v_mfma_f32_32x32x16_bf16 v[64:79], v[16:19], v[28:31], v[64:79]
  ds_read_b64_tr_b16 v[36:37], v241 offset:52224
  ds_read_b64_tr_b16 v[38:39], v241 offset:52992
  ds_read_b128 v[48:51], v238 offset:32768
  v_mfma_f32_32x32x16_bf16 v[80:95], v[16:19], v[32:35], v[80:95]
  ds_read_b128 v[52:55], v238 offset:36864
  ds_read_b64_tr_b16 v[40:41], v241 offset:52256
  ds_read_b64_tr_b16 v[42:43], v241 offset:53024
  s_add_u32 m0, s24, 36864
  s_mov_b32 s22, 884736
  buffer_load_dwordx4 v236, s[12:15], s22 offen offset:2048 lds
  v_mfma_f32_32x32x16_bf16 v[96:111], v[20:23], v[28:31], v[96:111]
  ds_read_b64_tr_b16 v[44:45], v242 offset:52288
  ds_read_b64_tr_b16 v[46:47], v242 offset:53056
  v_mfma_f32_32x32x16_bf16 v[112:127], v[20:23], v[32:35], v[112:127]
  v_mfma_f32_32x32x16_bf16 v[128:143], v[24:27], v[28:31], v[128:143]
  v_mfma_f32_32x32x16_bf16 v[144:159], v[24:27], v[32:35], v[144:159]
  s_waitcnt vmcnt(20) lgkmcnt(0)
  s_barrier
  v_mfma_f32_32x32x16_bf16 v[64:79], v[36:39], v[48:51], v[64:79]
  ds_read_b64_tr_b16 v[16:17], v241 offset:61440
  ds_read_b64_tr_b16 v[18:19], v241 offset:62208
  ds_read_b128 v[28:31], v239 offset:32768
  v_mfma_f32_32x32x16_bf16 v[80:95], v[36:39], v[52:55], v[80:95]
  ds_read_b128 v[32:35], v239 offset:36864
  ds_read_b64_tr_b16 v[20:21], v241 offset:61472
  ds_read_b64_tr_b16 v[22:23], v241 offset:62240
  s_add_u32 m0, s24, 49152
  s_mov_b32 s22, 983040
  buffer_load_dwordx4 v234, s[12:15], s22 offen lds
  v_mfma_f32_32x32x16_bf16 v[96:111], v[40:43], v[48:51], v[96:111]
  ds_read_b64_tr_b16 v[24:25], v242 offset:61504
  ds_read_b64_tr_b16 v[26:27], v242 offset:62272
  v_mfma_f32_32x32x16_bf16 v[112:127], v[40:43], v[52:55], v[112:127]
  s_add_u32 m0, s24, 49152
  s_mov_b32 s22, 983040
  buffer_load_dwordx4 v235, s[12:15], s22 offen offset:1024 lds
  v_mfma_f32_32x32x16_bf16 v[128:143], v[44:47], v[48:51], v[128:143]
  v_mfma_f32_32x32x16_bf16 v[144:159], v[44:47], v[52:55], v[144:159]
  s_add_u32 m0, s24, 49152
  s_mov_b32 s22, 983040
  buffer_load_dwordx4 v236, s[12:15], s22 offen offset:2048 lds
  s_waitcnt lgkmcnt(0)
  v_mfma_f32_32x32x16_bf16 v[64:79], v[16:19], v[28:31], v[64:79]
  ds_read_b64_tr_b16 v[36:37], v241 offset:64512
  ds_read_b64_tr_b16 v[38:39], v241 offset:65280
  ds_read_b128 v[48:51], v240 offset:32768
  v_mfma_f32_32x32x16_bf16 v[80:95], v[16:19], v[32:35], v[80:95]
  ds_read_b128 v[52:55], v240 offset:36864
  ds_read_b64_tr_b16 v[40:41], v241 offset:64544
  ds_read_b64_tr_b16 v[42:43], v241 offset:65312
  v_mfma_f32_32x32x16_bf16 v[96:111], v[20:23], v[28:31], v[96:111]
  ds_read_b64_tr_b16 v[44:45], v242 offset:64576
  ds_read_b64_tr_b16 v[46:47], v242 offset:65344
  v_mfma_f32_32x32x16_bf16 v[112:127], v[20:23], v[32:35], v[112:127]
  v_mfma_f32_32x32x16_bf16 v[128:143], v[24:27], v[28:31], v[128:143]
  v_mfma_f32_32x32x16_bf16 v[144:159], v[24:27], v[32:35], v[144:159]
  s_waitcnt vmcnt(16) lgkmcnt(0)
  s_barrier
  v_mfma_f32_32x32x16_bf16 v[64:79], v[36:39], v[48:51], v[64:79]
  ds_read_b64_tr_b16 v[16:17], v241 offset:0
  ds_read_b64_tr_b16 v[18:19], v241 offset:768
  ds_read_b128 v[28:31], v237 offset:0
  s_add_u32 m0, s23, 32768
  s_mov_b32 s21, 640
  buffer_load_dwordx4 v230, s[8:11], s21 offen lds
  v_mfma_f32_32x32x16_bf16 v[80:95], v[36:39], v[52:55], v[80:95]
  ds_read_b128 v[32:35], v237 offset:4096
  ds_read_b64_tr_b16 v[20:21], v241 offset:32
  ds_read_b64_tr_b16 v[22:23], v241 offset:800
  s_add_u32 m0, s23, 32768
  s_mov_b32 s21, 640
  buffer_load_dwordx4 v231, s[8:11], s21 offen offset:1024 lds
  v_mfma_f32_32x32x16_bf16 v[96:111], v[40:43], v[48:51], v[96:111]
  ds_read_b64_tr_b16 v[24:25], v242 offset:64
  ds_read_b64_tr_b16 v[26:27], v242 offset:832
  s_add_u32 m0, s23, 32768
  s_mov_b32 s21, 640
  buffer_load_dwordx4 v232, s[8:11], s21 offen offset:2048 lds
  v_mfma_f32_32x32x16_bf16 v[112:127], v[40:43], v[52:55], v[112:127]
  s_add_u32 m0, s23, 32768
  s_mov_b32 s21, 640
  buffer_load_dwordx4 v233, s[8:11], s21 offen offset:3072 lds
  v_mfma_f32_32x32x16_bf16 v[128:143], v[44:47], v[48:51], v[128:143]
  s_add_u32 m0, s24, 61440
  s_mov_b32 s22, 1081344
  buffer_load_dwordx4 v234, s[12:15], s22 offen lds
  v_mfma_f32_32x32x16_bf16 v[144:159], v[44:47], v[52:55], v[144:159]
  s_add_u32 m0, s24, 61440
  s_mov_b32 s22, 1081344
  buffer_load_dwordx4 v235, s[12:15], s22 offen offset:1024 lds
  s_waitcnt lgkmcnt(0)
  v_mfma_f32_32x32x16_bf16 v[64:79], v[16:19], v[28:31], v[64:79]
  ds_read_b64_tr_b16 v[36:37], v241 offset:3072
  ds_read_b64_tr_b16 v[38:39], v241 offset:3840
  ds_read_b128 v[48:51], v238 offset:0
  v_mfma_f32_32x32x16_bf16 v[80:95], v[16:19], v[32:35], v[80:95]
  ds_read_b128 v[52:55], v238 offset:4096
  ds_read_b64_tr_b16 v[40:41], v241 offset:3104
  ds_read_b64_tr_b16 v[42:43], v241 offset:3872
  s_add_u32 m0, s24, 61440
  s_mov_b32 s22, 1081344
  buffer_load_dwordx4 v236, s[12:15], s22 offen offset:2048 lds
  v_mfma_f32_32x32x16_bf16 v[96:111], v[20:23], v[28:31], v[96:111]
  ds_read_b64_tr_b16 v[44:45], v242 offset:3136
  ds_read_b64_tr_b16 v[46:47], v242 offset:3904
  v_mfma_f32_32x32x16_bf16 v[112:127], v[20:23], v[32:35], v[112:127]
  v_mfma_f32_32x32x16_bf16 v[128:143], v[24:27], v[28:31], v[128:143]
  v_mfma_f32_32x32x16_bf16 v[144:159], v[24:27], v[32:35], v[144:159]
  s_waitcnt vmcnt(20) lgkmcnt(0)
  s_barrier
  v_mfma_f32_32x32x16_bf16 v[64:79], v[36:39], v[48:51], v[64:79]
  ds_read_b64_tr_b16 v[16:17], v241 offset:12288
  ds_read_b64_tr_b16 v[18:19], v241 offset:13056
  ds_read_b128 v[28:31], v239 offset:0
  v_mfma_f32_32x32x16_bf16 v[80:95], v[36:39], v[52:55], v[80:95]
  ds_read_b128 v[32:35], v239 offset:4096
  ds_read_b64_tr_b16 v[20:21], v241 offset:12320
  ds_read_b64_tr_b16 v[22:23], v241 offset:13088
  s_add_u32 m0, s24, 0
  s_mov_b32 s22, 1179648
  buffer_load_dwordx4 v234, s[12:15], s22 offen lds
  v_mfma_f32_32x32x16_bf16 v[96:111], v[40:43], v[48:51], v[96:111]
  ds_read_b64_tr_b16 v[24:25], v242 offset:12352
  ds_read_b64_tr_b16 v[26:27], v242 offset:13120
  v_mfma_f32_32x32x16_bf16 v[112:127], v[40:43], v[52:55], v[112:127]
  s_add_u32 m0, s24, 0
  s_mov_b32 s22, 1179648
  buffer_load_dwordx4 v235, s[12:15], s22 offen offset:1024 lds
  v_mfma_f32_32x32x16_bf16 v[128:143], v[44:47], v[48:51], v[128:143]
  v_mfma_f32_32x32x16_bf16 v[144:159], v[44:47], v[52:55], v[144:159]
  s_add_u32 m0, s24, 0
  s_mov_b32 s22, 1179648
  buffer_load_dwordx4 v236, s[12:15], s22 offen offset:2048 lds
  s_waitcnt lgkmcnt(0)
  v_mfma_f32_32x32x16_bf16 v[64:79], v[16:19], v[28:31], v[64:79]
  ds_read_b64_tr_b16 v[36:37], v241 offset:15360
  ds_read_b64_tr_b16 v[38:39], v241 offset:16128
  ds_read_b128 v[48:51], v240 offset:0
  v_mfma_f32_32x32x16_bf16 v[80:95], v[16:19], v[32:35], v[80:95]
  ds_read_b128 v[52:55], v240 offset:4096
  ds_read_b64_tr_b16 v[40:41], v241 offset:15392
  ds_read_b64_tr_b16 v[42:43], v241 offset:16160
  v_mfma_f32_32x32x16_bf16 v[96:111], v[20:23], v[28:31], v[96:111]
  ds_read_b64_tr_b16 v[44:45], v242 offset:15424
  ds_read_b64_tr_b16 v[46:47], v242 offset:16192
  v_mfma_f32_32x32x16_bf16 v[112:127], v[20:23], v[32:35], v[112:127]
  v_mfma_f32_32x32x16_bf16 v[128:143], v[24:27], v[28:31], v[128:143]
  v_mfma_f32_32x32x16_bf16 v[144:159], v[24:27], v[32:35], v[144:159]
  s_waitcnt vmcnt(16) lgkmcnt(0)
  s_barrier
  v_mfma_f32_32x32x16_bf16 v[64:79], v[36:39], v[48:51], v[64:79]
  ds_read_b64_tr_b16 v[16:17], v241 offset:24576
  ds_read_b64_tr_b16 v[18:19], v241 offset:25344
  ds_read_b128 v[28:31], v237 offset:16384
  s_add_u32 m0, s23, 0
  s_mov_b32 s21, 768
  buffer_load_dwordx4 v230, s[8:11], s21 offen lds
  v_mfma_f32_32x32x16_bf16 v[80:95], v[36:39], v[52:55], v[80:95]
  ds_read_b128 v[32:35], v237 offset:20480
  ds_read_b64_tr_b16 v[20:21], v241 offset:24608
  ds_read_b64_tr_b16 v[22:23], v241 offset:25376
  s_add_u32 m0, s23, 0
  s_mov_b32 s21, 768
  buffer_load_dwordx4 v231, s[8:11], s21 offen offset:1024 lds
  v_mfma_f32_32x32x16_bf16 v[96:111], v[40:43], v[48:51], v[96:111]
  ds_read_b64_tr_b16 v[24:25], v242 offset:24640
  ds_read_b64_tr_b16 v[26:27], v242 offset:25408
  s_add_u32 m0, s23, 0
  s_mov_b32 s21, 768
  buffer_load_dwordx4 v232, s[8:11], s21 offen offset:2048 lds
  v_mfma_f32_32x32x16_bf16 v[112:127], v[40:43], v[52:55], v[112:127]
  s_add_u32 m0, s23, 0
  s_mov_b32 s21, 768
  buffer_load_dwordx4 v233, s[8:11], s21 offen offset:3072 lds
  v_mfma_f32_32x32x16_bf16 v[128:143], v[44:47], v[48:51], v[128:143]
  s_add_u32 m0, s24, 12288
  s_mov_b32 s22, 1277952
  buffer_load_dwordx4 v234, s[12:15], s22 offen lds
  v_mfma_f32_32x32x16_bf16 v[144:159], v[44:47], v[52:55], v[144:159]
  s_add_u32 m0, s24, 12288
  s_mov_b32 s22, 1277952
  buffer_load_dwordx4 v235, s[12:15], s22 offen offset:1024 lds
  s_waitcnt lgkmcnt(0)
  v_mfma_f32_32x32x16_bf16 v[64:79], v[16:19], v[28:31], v[64:79]
  ds_read_b64_tr_b16 v[36:37], v241 offset:27648
  ds_read_b64_tr_b16 v[38:39], v241 offset:28416
  ds_read_b128 v[48:51], v238 offset:16384
  v_mfma_f32_32x32x16_bf16 v[80:95], v[16:19], v[32:35], v[80:95]
  ds_read_b128 v[52:55], v238 offset:20480
  ds_read_b64_tr_b16 v[40:41], v241 offset:27680
  ds_read_b64_tr_b16 v[42:43], v241 offset:28448
  s_add_u32 m0, s24, 12288
  s_mov_b32 s22, 1277952
  buffer_load_dwordx4 v236, s[12:15], s22 offen offset:2048 lds
  v_mfma_f32_32x32x16_bf16 v[96:111], v[20:23], v[28:31], v[96:111]
  ds_read_b64_tr_b16 v[44:45], v242 offset:27712
  ds_read_b64_tr_b16 v[46:47], v242 offset:28480
  v_mfma_f32_32x32x16_bf16 v[112:127], v[20:23], v[32:35], v[112:127]
  v_mfma_f32_32x32x16_bf16 v[128:143], v[24:27], v[28:31], v[128:143]
  v_mfma_f32_32x32x16_bf16 v[144:159], v[24:27], v[32:35], v[144:159]
  s_waitcnt vmcnt(20) lgkmcnt(0)
  s_barrier
  v_mfma_f32_32x32x16_bf16 v[64:79], v[36:39], v[48:51], v[64:79]
  ds_read_b64_tr_b16 v[16:17], v241 offset:36864
  ds_read_b64_tr_b16 v[18:19], v241 offset:37632
  ds_read_b128 v[28:31], v239 offset:16384
  v_and_b32 v254, 63, v0
  v_lshlrev_b32 v254, 4, v254
  v_mfma_f32_32x32x16_bf16 v[80:95], v[36:39], v[52:55], v[80:95]
  ds_read_b128 v[32:35], v239 offset:20480
  ds_read_b64_tr_b16 v[20:21], v241 offset:36896
  ds_read_b64_tr_b16 v[22:23], v241 offset:37664
  s_and_b32 s97, s98, 7
  s_lshl_b32 s97, s97, 10
  v_mfma_f32_32x32x16_bf16 v[96:111], v[40:43], v[48:51], v[96:111]
  ds_read_b64_tr_b16 v[24:25], v242 offset:36928
  ds_read_b64_tr_b16 v[26:27], v242 offset:37696
  s_add_u32 s97, s97, 32768
  s_cmp_eq_u32 s20, 0
  v_mfma_f32_32x32x16_bf16 v[112:127], v[40:43], v[52:55], v[112:127]
  s_cselect_b32 s97, s97, 0x40000000
  buffer_load_dwordx4 v[250:253], v254, s[92:95], s97 offen sc1
  v_mfma_f32_32x32x16_bf16 v[128:143], v[44:47], v[48:51], v[128:143]
  s_add_u32 m0, s24, 24576
  s_mov_b32 s22, 1376256
  buffer_load_dwordx4 v234, s[12:15], s22 offen lds
  v_mfma_f32_32x32x16_bf16 v[144:159], v[44:47], v[52:55], v[144:159]
  s_add_u32 m0, s24, 24576
  s_mov_b32 s22, 1376256
  buffer_load_dwordx4 v235, s[12:15], s22 offen offset:1024 lds
  s_waitcnt lgkmcnt(0)
  v_mfma_f32_32x32x16_bf16 v[64:79], v[16:19], v[28:31], v[64:79]
  ds_read_b64_tr_b16 v[36:37], v241 offset:39936
  ds_read_b64_tr_b16 v[38:39], v241 offset:40704
  ds_read_b128 v[48:51], v240 offset:16384
  v_mfma_f32_32x32x16_bf16 v[80:95], v[16:19], v[32:35], v[80:95]
  ds_read_b128 v[52:55], v240 offset:20480
  ds_read_b64_tr_b16 v[40:41], v241 offset:39968
  ds_read_b64_tr_b16 v[42:43], v241 offset:40736
  s_add_u32 m0, s24, 24576
  s_mov_b32 s22, 1376256
  buffer_load_dwordx4 v236, s[12:15], s22 offen offset:2048 lds
  v_mfma_f32_32x32x16_bf16 v[96:111], v[20:23], v[28:31], v[96:111]
  ds_read_b64_tr_b16 v[44:45], v242 offset:40000
  ds_read_b64_tr_b16 v[46:47], v242 offset:40768
  v_mfma_f32_32x32x16_bf16 v[112:127], v[20:23], v[32:35], v[112:127]
  v_mfma_f32_32x32x16_bf16 v[128:143], v[24:27], v[28:31], v[128:143]
  v_mfma_f32_32x32x16_bf16 v[144:159], v[24:27], v[32:35], v[144:159]
  s_waitcnt vmcnt(17) lgkmcnt(0)
  s_barrier
  v_mfma_f32_32x32x16_bf16 v[64:79], v[36:39], v[48:51], v[64:79]
  ds_read_b64_tr_b16 v[16:17], v241 offset:49152
  ds_read_b64_tr_b16 v[18:19], v241 offset:49920
  ds_read_b128 v[28:31], v237 offset:32768
  s_add_u32 m0, s23, 16384
  s_mov_b32 s21, 896
  buffer_load_dwordx4 v230, s[8:11], s21 offen lds
  v_mfma_f32_32x32x16_bf16 v[80:95], v[36:39], v[52:55], v[80:95]
  ds_read_b128 v[32:35], v237 offset:36864
  ds_read_b64_tr_b16 v[20:21], v241 offset:49184
  ds_read_b64_tr_b16 v[22:23], v241 offset:49952
  s_add_u32 m0, s23, 16384
  s_mov_b32 s21, 896
  buffer_load_dwordx4 v231, s[8:11], s21 offen offset:1024 lds
  v_mfma_f32_32x32x16_bf16 v[96:111], v[40:43], v[48:51], v[96:111]
  ds_read_b64_tr_b16 v[24:25], v242 offset:49216
  ds_read_b64_tr_b16 v[26:27], v242 offset:49984
  s_add_u32 m0, s23, 16384
  s_mov_b32 s21, 896
  buffer_load_dwordx4 v232, s[8:11], s21 offen offset:2048 lds
  v_mfma_f32_32x32x16_bf16 v[112:127], v[40:43], v[52:55], v[112:127]
  s_add_u32 m0, s23, 16384
  s_mov_b32 s21, 896
  buffer_load_dwordx4 v233, s[8:11], s21 offen offset:3072 lds
  v_mfma_f32_32x32x16_bf16 v[128:143], v[44:47], v[48:51], v[128:143]
  s_add_u32 m0, s24, 36864
  s_mov_b32 s22, 1474560
  buffer_load_dwordx4 v234, s[12:15], s22 offen lds
  v_mfma_f32_32x32x16_bf16 v[144:159], v[44:47], v[52:55], v[144:159]
  s_add_u32 m0, s24, 36864
  s_mov_b32 s22, 1474560
  buffer_load_dwordx4 v235, s[12:15], s22 offen offset:1024 lds
  s_waitcnt lgkmcnt(0)
  v_mfma_f32_32x32x16_bf16 v[64:79], v[16:19], v[28:31], v[64:79]
  ds_read_b64_tr_b16 v[36:37], v241 offset:52224
  ds_read_b64_tr_b16 v[38:39], v241 offset:52992
  ds_read_b128 v[48:51], v238 offset:32768
  v_mfma_f32_32x32x16_bf16 v[80:95], v[16:19], v[32:35], v[80:95]
  ds_read_b128 v[52:55], v238 offset:36864
  ds_read_b64_tr_b16 v[40:41], v241 offset:52256
  ds_read_b64_tr_b16 v[42:43], v241 offset:53024
  s_add_u32 m0, s24, 36864
  s_mov_b32 s22, 1474560
  buffer_load_dwordx4 v236, s[12:15], s22 offen offset:2048 lds
  v_mfma_f32_32x32x16_bf16 v[96:111], v[20:23], v[28:31], v[96:111]
  ds_read_b64_tr_b16 v[44:45], v242 offset:52288
  ds_read_b64_tr_b16 v[46:47], v242 offset:53056
  v_mfma_f32_32x32x16_bf16 v[112:127], v[20:23], v[32:35], v[112:127]
  v_mfma_f32_32x32x16_bf16 v[128:143], v[24:27], v[28:31], v[128:143]
  v_mfma_f32_32x32x16_bf16 v[144:159], v[24:27], v[32:35], v[144:159]
  s_waitcnt vmcnt(21) lgkmcnt(0)
  s_waitcnt vmcnt(10)
  s_cmp_lg_u32 s20, 0
  s_cbranch_scc1 K_wok2
  s_mov_b32 s96, 0
K_w1:
  v_xor_b32 v250, s90, v250
  v_xor_b32 v251, s90, v251
  v_xor_b32 v252, s90, v252
  v_xor_b32 v253, s90, v253
  v_or3_b32 v250, v250, v251, v252
  v_or_b32 v250, v250, v253
  v_cmp_ne_u32 vcc, 0, v250
  s_cbranch_vccz K_wok2
  s_add_u32 s96, s96, 1
  s_cmp_gt_u32 s96, 20000
  s_cbranch_scc1 K_wok2
  v_and_b32 v254, 63, v0
  v_lshlrev_b32 v254, 4, v254
  s_and_b32 s97, s98, 7
  s_lshl_b32 s97, s97, 10
  s_add_u32 s97, s97, 32768
  s_sleep 2
  buffer_load_dwordx4 v[250:253], v254, s[92:95], s97 offen sc1
  s_waitcnt vmcnt(0)
  s_branch K_w1
K_wok2:
  s_barrier
  v_mfma_f32_32x32x16_bf16 v[64:79], v[36:39], v[48:51], v[64:79]
  ds_read_b64_tr_b16 v[16:17], v241 offset:61440
  ds_read_b64_tr_b16 v[18:19], v241 offset:62208
  ds_read_b128 v[28:31], v239 offset:32768
  s_or_b32 s97, s98, s20
  s_cmp_eq_u32 s97, 0
  s_cselect_b32 s97, 0, 0x40000000
  v_mov_b32 v249, s90
  v_mov_b32 v254, 0
  s_mov_b64 exec, 1
  buffer_store_dword v249, v254, s[92:95], s97 offen sc1
  s_mov_b64 exec, -1
  s_lshl_b32 s28, s63, 14
  v_mfma_f32_32x32x16_bf16 v[80:95], v[36:39], v[52:55], v[80:95]
  ds_read_b128 v[32:35], v239 offset:36864
  ds_read_b64_tr_b16 v[20:21], v241 offset:61472
  ds_read_b64_tr_b16 v[22:23], v241 offset:62240
  s_lshl_b32 s29, s20, 12
  s_add_u32 s28, s28, s29
  s_add_u32 m0, s29, 122880
  v_lshlrev_b32 v4, 4, v1
  buffer_load_dwordx4 v4, s[36:39], s28 offen offset:0 sc1 lds
  buffer_load_dwordx4 v4, s[36:39], s28 offen offset:1024 sc1 lds
  buffer_load_dwordx4 v4, s[36:39], s28 offen offset:2048 sc1 lds
  buffer_load_dwordx4 v4, s[36:39], s28 offen offset:3072 sc1 lds
  s_add_u32 m0, s29, 139264
  v_mfma_f32_32x32x16_bf16 v[96:111], v[40:43], v[48:51], v[96:111]
  ds_read_b64_tr_b16 v[24:25], v242 offset:61504
  ds_read_b64_tr_b16 v[26:27], v242 offset:62272
  s_nop 0
  buffer_load_dwordx4 v4, s[48:51], s28 offen offset:0 sc1 lds
  buffer_load_dwordx4 v4, s[48:51], s28 offen offset:1024 sc1 lds
  buffer_load_dwordx4 v4, s[48:51], s28 offen offset:2048 sc1 lds
  buffer_load_dwordx4 v4, s[48:51], s28 offen offset:3072 sc1 lds
  s_add_u32 s64, s88, 0x1600000
  s_addc_u32 s65, s89, 0
  s_and_b32 s65, s65, 0xffff
  s_mov_b32 s66, 0x1e0000
  v_mfma_f32_32x32x16_bf16 v[112:127], v[40:43], v[52:55], v[112:127]
  s_mov_b32 s67, 0x20000
  s_lshr_b32 s60, s98, 5
  s_mul_i32 s62, s20, 96
  s_add_u32 s60, s60, s62
  s_mul_i32 s61, s60, 5120
  v_and_b32 v243, 63, v0
  v_lshlrev_b32 v243, 4, v243
  v_mfma_f32_32x32x16_bf16 v[128:143], v[44:47], v[48:51], v[128:143]
  s_add_u32 m0, s24, 49152
  s_mov_b32 s22, 1572864
  buffer_load_dwordx4 v234, s[12:15], s22 offen lds
  v_mfma_f32_32x32x16_bf16 v[144:159], v[44:47], v[52:55], v[144:159]
  s_add_u32 m0, s24, 49152
  s_mov_b32 s22, 1572864
  buffer_load_dwordx4 v235, s[12:15], s22 offen offset:1024 lds
  s_waitcnt lgkmcnt(0)
  v_mfma_f32_32x32x16_bf16 v[64:79], v[16:19], v[28:31], v[64:79]
  ds_read_b64_tr_b16 v[36:37], v241 offset:64512
  ds_read_b64_tr_b16 v[38:39], v241 offset:65280
  ds_read_b128 v[48:51], v240 offset:32768
  v_mfma_f32_32x32x16_bf16 v[80:95], v[16:19], v[32:35], v[80:95]
  ds_read_b128 v[52:55], v240 offset:36864
  ds_read_b64_tr_b16 v[40:41], v241 offset:64544
  ds_read_b64_tr_b16 v[42:43], v241 offset:65312
  s_add_u32 m0, s24, 49152
  s_mov_b32 s22, 1572864
  buffer_load_dwordx4 v236, s[12:15], s22 offen offset:2048 lds
  v_mfma_f32_32x32x16_bf16 v[96:111], v[20:23], v[28:31], v[96:111]
  ds_read_b64_tr_b16 v[44:45], v242 offset:64576
  ds_read_b64_tr_b16 v[46:47], v242 offset:65344
  v_mfma_f32_32x32x16_bf16 v[112:127], v[20:23], v[32:35], v[112:127]
  v_mfma_f32_32x32x16_bf16 v[128:143], v[24:27], v[28:31], v[128:143]
  v_mfma_f32_32x32x16_bf16 v[144:159], v[24:27], v[32:35], v[144:159]
  s_waitcnt vmcnt(22) lgkmcnt(0)
  s_barrier
  v_mfma_f32_32x32x16_bf16 v[64:79], v[36:39], v[48:51], v[64:79]
  s_add_u32 m0, s23, 32768
  s_mov_b32 s21, 1024
  buffer_load_dwordx4 v230, s[8:11], s21 offen lds
  v_mfma_f32_32x32x16_bf16 v[80:95], v[36:39], v[52:55], v[80:95]
  s_add_u32 m0, s23, 32768
  s_mov_b32 s21, 1024
  buffer_load_dwordx4 v231, s[8:11], s21 offen offset:1024 lds
  v_mfma_f32_32x32x16_bf16 v[96:111], v[40:43], v[48:51], v[96:111]
  s_add_u32 m0, s23, 32768
  s_mov_b32 s21, 1024
  buffer_load_dwordx4 v232, s[8:11], s21 offen offset:2048 lds
  v_mfma_f32_32x32x16_bf16 v[112:127], v[40:43], v[52:55], v[112:127]
  s_add_u32 m0, s23, 32768
  s_mov_b32 s21, 1024
  buffer_load_dwordx4 v233, s[8:11], s21 offen offset:3072 lds
  v_mfma_f32_32x32x16_bf16 v[128:143], v[44:47], v[48:51], v[128:143]
  s_add_u32 m0, s24, 61440
  s_mov_b32 s22, 1671168
  buffer_load_dwordx4 v234, s[12:15], s22 offen lds
  v_mfma_f32_32x32x16_bf16 v[144:159], v[44:47], v[52:55], v[144:159]
  s_add_u32 m0, s24, 61440
  s_mov_b32 s22, 1671168
  buffer_load_dwordx4 v235, s[12:15], s22 offen offset:1024 lds
  s_waitcnt vmcnt(9)
  s_cmp_ge_u32 s63, 162
  s_cbranch_scc1 K_noa23
  s_add_u32 s4, s88, 0x1000000
  s_addc_u32 s5, s89, 0
  s_and_b32 s5, s5, 0xffff
  s_mov_b32 s6, 0x288000
  s_mov_b32 s7, 0x20000
  s_barrier
  v_lshlrev_b32 v4, 11, v3
  v_lshl_add_u32 v4, v2, 4, v4
  s_lshl_b32 s28, s20, 2
  s_add_u32 s28, s28, 122880
  v_add_u32 v8, s28, v4
  ds_read_b32 v16, v8 offset:0
  ds_read_b32 v17, v8 offset:512
  ds_read_b32 v18, v8 offset:1024
  ds_read_b32 v19, v8 offset:1536
  ds_read_b32 v20, v8 offset:4096
  ds_read_b32 v21, v8 offset:4608
  ds_read_b32 v22, v8 offset:5120
  ds_read_b32 v23, v8 offset:5632
  ds_read_b32 v24, v8 offset:8192
  ds_read_b32 v25, v8 offset:8704
  ds_read_b32 v26, v8 offset:9216
  ds_read_b32 v27, v8 offset:9728
  ds_read_b32 v28, v8 offset:12288
  ds_read_b32 v29, v8 offset:12800
  ds_read_b32 v30, v8 offset:13312
  ds_read_b32 v31, v8 offset:13824
  s_lshl_b32 s28, s20, 12
  s_add_u32 s28, s28, 139264
  v_lshlrev_b32 v5, 9, v3
  v_lshl_add_u32 v5, v2, 2, v5
  v_add_u32 v5, s28, v5
  s_waitcnt lgkmcnt(0)
  v_mfma_f32_32x32x16_bf16 v[32:47], v[16:19], a[216:219], 0
  v_mfma_f32_32x32x16_bf16 v[48:63], v[16:19], a[232:235], 0
  v_mfma_f32_32x32x16_bf16 v[32:47], v[20:23], a[220:223], v[32:47]
  v_mfma_f32_32x32x16_bf16 v[48:63], v[20:23], a[236:239], v[48:63]
  v_mfma_f32_32x32x16_bf16 v[32:47], v[24:27], a[224:227], v[32:47]
  v_mfma_f32_32x32x16_bf16 v[48:63], v[24:27], a[240:243], v[48:63]
  v_mfma_f32_32x32x16_bf16 v[32:47], v[28:31], a[228:231], v[32:47]
  v_mfma_f32_32x32x16_bf16 v[48:63], v[28:31], a[244:247], v[48:63]
  s_add_u32 s60, s61, 0
  buffer_load_dwordx4 a[0:3], v243, s[64:67], s60 offen sc1
  ds_read_b32 v220, v5 offset:0
  ds_read_b32 v221, v5 offset:128
  ds_read_b32 v222, v5 offset:256
  ds_read_b32 v223, v5 offset:384
  s_nop 5
  v_pk_mul_f32 v[6:7], v[48:49], v[176:177]
  v_pk_mul_f32 v[10:11], v[48:49], v[160:161]
  v_pk_fma_f32 v[6:7], v[32:33], v[160:161], v[6:7] neg_lo:[0,0,1] neg_hi:[0,0,1]
  v_pk_fma_f32 v[10:11], v[32:33], v[176:177], v[10:11]
  buffer_load_dwordx4 a[4:7], v243, s[64:67], s60 offen offset:1024 sc1
  v_pk_mul_f32 v[12:13], v[50:51], v[178:179]
  v_pk_mul_f32 v[14:15], v[50:51], v[162:163]
  v_pk_fma_f32 v[12:13], v[34:35], v[162:163], v[12:13] neg_lo:[0,0,1] neg_hi:[0,0,1]
  v_pk_fma_f32 v[14:15], v[34:35], v[178:179], v[14:15]
  v_cvt_pk_bf16_f32 v32, v6, v10
  v_cvt_pk_bf16_f32 v33, v7, v11
  v_cvt_pk_bf16_f32 v34, v12, v14
  buffer_load_dwordx4 a[8:11], v243, s[64:67], s60 offen offset:2048 sc1
  v_cvt_pk_bf16_f32 v35, v13, v15
  s_nop 1
  v_mfma_f32_32x32x16_bf16 v[204:219], a[216:219], v[32:35], 0
  v_mfma_f32_32x32x16_bf16 v[16:31], a[232:235], v[32:35], 0
  v_pk_mul_f32 v[6:7], v[52:53], v[180:181]
  v_pk_mul_f32 v[10:11], v[52:53], v[164:165]
  v_pk_fma_f32 v[6:7], v[36:37], v[164:165], v[6:7] neg_lo:[0,0,1] neg_hi:[0,0,1]
  v_pk_fma_f32 v[10:11], v[36:37], v[180:181], v[10:11]
  v_pk_mul_f32 v[12:13], v[54:55], v[182:183]
  buffer_load_dwordx4 a[12:15], v243, s[64:67], s60 offen offset:3072 sc1
  v_pk_mul_f32 v[14:15], v[54:55], v[166:167]
  v_pk_fma_f32 v[12:13], v[38:39], v[166:167], v[12:13] neg_lo:[0,0,1] neg_hi:[0,0,1]
  v_pk_fma_f32 v[14:15], v[38:39], v[182:183], v[14:15]
  v_cvt_pk_bf16_f32 v36, v6, v10
  v_cvt_pk_bf16_f32 v37, v7, v11
  v_cvt_pk_bf16_f32 v38, v12, v14
  v_cvt_pk_bf16_f32 v39, v13, v15
  s_add_u32 s60, s60, 4096
  buffer_load_dwordx4 a[16:19], v243, s[64:67], s60 offen sc1
  v_mfma_f32_32x32x16_bf16 v[204:219], a[220:223], v[36:39], v[204:219]
  v_mfma_f32_32x32x16_bf16 v[16:31], a[236:239], v[36:39], v[16:31]
  v_pk_mul_f32 v[6:7], v[56:57], v[184:185]
  v_pk_mul_f32 v[10:11], v[56:57], v[168:169]
  v_pk_fma_f32 v[6:7], v[40:41], v[168:169], v[6:7] neg_lo:[0,0,1] neg_hi:[0,0,1]
  v_pk_fma_f32 v[10:11], v[40:41], v[184:185], v[10:11]
  v_pk_mul_f32 v[12:13], v[58:59], v[186:187]
  v_pk_mul_f32 v[14:15], v[58:59], v[170:171]
  s_add_u32 s60, s61, 40960
  buffer_load_dwordx4 a[20:23], v243, s[64:67], s60 offen sc1
  v_pk_fma_f32 v[12:13], v[42:43], v[170:171], v[12:13] neg_lo:[0,0,1] neg_hi:[0,0,1]
  v_pk_fma_f32 v[14:15], v[42:43], v[186:187], v[14:15]
  v_cvt_pk_bf16_f32 v40, v6, v10
  v_cvt_pk_bf16_f32 v41, v7, v11
  v_cvt_pk_bf16_f32 v42, v12, v14
  v_cvt_pk_bf16_f32 v43, v13, v15
  s_nop 1
  v_mfma_f32_32x32x16_bf16 v[204:219], a[224:227], v[40:43], v[204:219]
  buffer_load_dwordx4 a[24:27], v243, s[64:67], s60 offen offset:1024 sc1
  v_mfma_f32_32x32x16_bf16 v[16:31], a[240:243], v[40:43], v[16:31]
  v_pk_mul_f32 v[6:7], v[60:61], v[188:189]
  v_pk_mul_f32 v[10:11], v[60:61], v[172:173]
  v_pk_fma_f32 v[6:7], v[44:45], v[172:173], v[6:7] neg_lo:[0,0,1] neg_hi:[0,0,1]
  v_pk_fma_f32 v[10:11], v[44:45], v[188:189], v[10:11]
  v_pk_mul_f32 v[12:13], v[62:63], v[190:191]
  v_pk_mul_f32 v[14:15], v[62:63], v[174:175]
  v_pk_fma_f32 v[12:13], v[46:47], v[174:175], v[12:13] neg_lo:[0,0,1] neg_hi:[0,0,1]
  buffer_load_dwordx4 a[28:31], v243, s[64:67], s60 offen offset:2048 sc1
  v_pk_fma_f32 v[14:15], v[46:47], v[190:191], v[14:15]
  v_cvt_pk_bf16_f32 v44, v6, v10
  v_cvt_pk_bf16_f32 v45, v7, v11
  v_cvt_pk_bf16_f32 v46, v12, v14
  v_cvt_pk_bf16_f32 v47, v13, v15
  s_nop 1
  v_mfma_f32_32x32x16_bf16 v[204:219], a[228:231], v[44:47], v[204:219]
  v_mfma_f32_32x32x16_bf16 v[16:31], a[244:247], v[44:47], v[16:31]
  buffer_load_dwordx4 a[32:35], v243, s[64:67], s60 offen offset:3072 sc1
  ds_read_b32 v224, v5 offset:1024
  ds_read_b32 v225, v5 offset:1152
  ds_read_b32 v226, v5 offset:1280
  ds_read_b32 v227, v5 offset:1408
  s_waitcnt lgkmcnt(4)
  v_lshlrev_b32 v6, 16, v220
  v_lshlrev_b32 v7, 16, v221
  v_and_b32 v10, 0xffff0000, v220
  s_add_u32 s60, s60, 4096
  buffer_load_dwordx4 a[36:39], v243, s[64:67], s60 offen sc1
  v_and_b32 v11, 0xffff0000, v221
  v_pk_mul_f32 v[12:13], v[16:17], v[10:11]
  v_pk_mul_f32 v[14:15], v[16:17], v[6:7]
  v_pk_fma_f32 v[12:13], v[204:205], v[6:7], v[12:13] neg_lo:[0,0,1] neg_hi:[0,0,1]
  v_pk_fma_f32 v[14:15], v[204:205], v[10:11], v[14:15]
  v_cvt_pk_bf16_f32 v204, v12, -v14
  v_cvt_pk_bf16_f32 v205, v13, -v15
  s_add_u32 s60, s61, 81920
  buffer_load_dwordx4 a[40:43], v243, s[64:67], s60 offen sc1
  v_lshlrev_b32 v6, 16, v222
  v_lshlrev_b32 v7, 16, v223
  v_and_b32 v10, 0xffff0000, v222
  v_and_b32 v11, 0xffff0000, v223
  v_pk_mul_f32 v[12:13], v[18:19], v[10:11]
  v_pk_mul_f32 v[14:15], v[18:19], v[6:7]
  v_pk_fma_f32 v[12:13], v[206:207], v[6:7], v[12:13] neg_lo:[0,0,1] neg_hi:[0,0,1]
  v_pk_fma_f32 v[14:15], v[206:207], v[10:11], v[14:15]
  buffer_load_dwordx4 a[44:47], v243, s[64:67], s60 offen offset:1024 sc1
  v_cvt_pk_bf16_f32 v206, v12, -v14
  v_cvt_pk_bf16_f32 v207, v13, -v15
  s_nop 1
  v_mfma_f32_32x32x16_bf16 v[32:47], v[204:207], a[216:219], 0
  v_mfma_f32_32x32x16_bf16 v[48:63], v[204:207], a[232:235], 0
  ds_read_b32 v220, v5 offset:2048
  ds_read_b32 v221, v5 offset:2176
  ds_read_b32 v222, v5 offset:2304
  ds_read_b32 v223, v5 offset:2432
  buffer_load_dwordx4 a[48:51], v243, s[64:67], s60 offen offset:2048 sc1
  s_waitcnt lgkmcnt(4)
  v_lshlrev_b32 v6, 16, v224
  v_lshlrev_b32 v7, 16, v225
  v_and_b32 v10, 0xffff0000, v224
  v_and_b32 v11, 0xffff0000, v225
  v_pk_mul_f32 v[12:13], v[20:21], v[10:11]
  v_pk_mul_f32 v[14:15], v[20:21], v[6:7]
  buffer_load_dwordx4 a[52:55], v243, s[64:67], s60 offen offset:3072 sc1
  v_pk_fma_f32 v[12:13], v[208:209], v[6:7], v[12:13] neg_lo:[0,0,1] neg_hi:[0,0,1]
  v_pk_fma_f32 v[14:15], v[208:209], v[10:11], v[14:15]
  v_cvt_pk_bf16_f32 v208, v12, -v14
  v_cvt_pk_bf16_f32 v209, v13, -v15
  v_lshlrev_b32 v6, 16, v226
  v_lshlrev_b32 v7, 16, v227
  v_and_b32 v10, 0xffff0000, v226
  v_and_b32 v11, 0xffff0000, v227
  s_add_u32 s60, s60, 4096
  buffer_load_dwordx4 a[56:59], v243, s[64:67], s60 offen sc1
  v_pk_mul_f32 v[12:13], v[22:23], v[10:11]
  v_pk_mul_f32 v[14:15], v[22:23], v[6:7]
  v_pk_fma_f32 v[12:13], v[210:211], v[6:7], v[12:13] neg_lo:[0,0,1] neg_hi:[0,0,1]
  v_pk_fma_f32 v[14:15], v[210:211], v[10:11], v[14:15]
  v_cvt_pk_bf16_f32 v210, v12, -v14
  v_cvt_pk_bf16_f32 v211, v13, -v15
  s_nop 1
  v_mfma_f32_32x32x16_bf16 v[32:47], v[208:211], a[220:223], v[32:47]
  s_add_u32 s60, s61, 122880
  buffer_load_dwordx4 a[60:63], v243, s[64:67], s60 offen sc1
  v_mfma_f32_32x32x16_bf16 v[48:63], v[208:211], a[236:239], v[48:63]
  ds_read_b32 v224, v5 offset:3072
  ds_read_b32 v225, v5 offset:3200
  ds_read_b32 v226, v5 offset:3328
  ds_read_b32 v227, v5 offset:3456
  s_waitcnt lgkmcnt(4)
  v_lshlrev_b32 v6, 16, v220
  v_lshlrev_b32 v7, 16, v221
  buffer_load_dwordx4 a[64:67], v243, s[64:67], s60 offen offset:1024 sc1
  v_and_b32 v10, 0xffff0000, v220
  v_and_b32 v11, 0xffff0000, v221
  v_pk_mul_f32 v[12:13], v[24:25], v[10:11]
  v_pk_mul_f32 v[14:15], v[24:25], v[6:7]
  v_pk_fma_f32 v[12:13], v[212:213], v[6:7], v[12:13] neg_lo:[0,0,1] neg_hi:[0,0,1]
  v_pk_fma_f32 v[14:15], v[212:213], v[10:11], v[14:15]
  v_cvt_pk_bf16_f32 v212, v12, -v14
  buffer_load_dwordx4 a[68:71], v243, s[64:67], s60 offen offset:2048 sc1
  v_cvt_pk_bf16_f32 v213, v13, -v15
  v_lshlrev_b32 v6, 16, v222
  v_lshlrev_b32 v7, 16, v223
  v_and_b32 v10, 0xffff0000, v222
  v_and_b32 v11, 0xffff0000, v223
  v_pk_mul_f32 v[12:13], v[26:27], v[10:11]
  v_pk_mul_f32 v[14:15], v[26:27], v[6:7]
  v_pk_fma_f32 v[12:13], v[214:215], v[6:7], v[12:13] neg_lo:[0,0,1] neg_hi:[0,0,1]
  buffer_load_dwordx4 a[72:75], v243, s[64:67], s60 offen offset:3072 sc1
  v_pk_fma_f32 v[14:15], v[214:215], v[10:11], v[14:15]
  v_cvt_pk_bf16_f32 v214, v12, -v14
  v_cvt_pk_bf16_f32 v215, v13, -v15
  s_nop 1
  v_mfma_f32_32x32x16_bf16 v[32:47], v[212:215], a[224:227], v[32:47]
  v_mfma_f32_32x32x16_bf16 v[48:63], v[212:215], a[240:243], v[48:63]
  s_waitcnt lgkmcnt(0)
  v_lshlrev_b32 v6, 16, v224
  s_add_u32 s60, s60, 4096
  buffer_load_dwordx4 a[76:79], v243, s[64:67], s60 offen sc1
  v_lshlrev_b32 v7, 16, v225
  v_and_b32 v10, 0xffff0000, v224
  v_and_b32 v11, 0xffff0000, v225
  v_pk_mul_f32 v[12:13], v[28:29], v[10:11]
  v_pk_mul_f32 v[14:15], v[28:29], v[6:7]
  v_pk_fma_f32 v[12:13], v[216:217], v[6:7], v[12:13] neg_lo:[0,0,1] neg_hi:[0,0,1]
  v_pk_fma_f32 v[14:15], v[216:217], v[10:11], v[14:15]
  v_cvt_pk_bf16_f32 v216, v12, -v14
  s_add_u32 s60, s61, 163840
  buffer_load_dwordx4 a[80:83], v243, s[64:67], s60 offen sc1
  v_cvt_pk_bf16_f32 v217, v13, -v15
  v_lshlrev_b32 v6, 16, v226
  v_lshlrev_b32 v7, 16, v227
  v_and_b32 v10, 0xffff0000, v226
  v_and_b32 v11, 0xffff0000, v227
  v_pk_mul_f32 v[12:13], v[30:31], v[10:11]
  v_pk_mul_f32 v[14:15], v[30:31], v[6:7]
  buffer_load_dwordx4 a[84:87], v243, s[64:67], s60 offen offset:1024 sc1
  v_pk_fma_f32 v[12:13], v[218:219], v[6:7], v[12:13] neg_lo:[0,0,1] neg_hi:[0,0,1]
  v_pk_fma_f32 v[14:15], v[218:219], v[10:11], v[14:15]
  v_cvt_pk_bf16_f32 v218, v12, -v14
  v_cvt_pk_bf16_f32 v219, v13, -v15
  s_nop 1
  v_mfma_f32_32x32x16_bf16 v[32:47], v[216:219], a[228:231], v[32:47]
  v_mfma_f32_32x32x16_bf16 v[48:63], v[216:219], a[244:247], v[48:63]
  s_nop 11
  v_pk_mul_f32 v[6:7], v[48:49], v[176:177]
  v_pk_mul_f32 v[10:11], v[48:49], v[160:161]
  buffer_load_dwordx4 a[88:91], v243, s[64:67], s60 offen offset:2048 sc1
  v_pk_fma_f32 v[6:7], v[32:33], v[160:161], v[6:7] neg_lo:[0,0,1] neg_hi:[0,0,1]
  v_pk_fma_f32 v[10:11], v[32:33], v[176:177], v[10:11]
  v_pk_mul_f32 v[12:13], v[50:51], v[178:179]
  v_pk_mul_f32 v[14:15], v[50:51], v[162:163]
  v_pk_fma_f32 v[12:13], v[34:35], v[162:163], v[12:13] neg_lo:[0,0,1] neg_hi:[0,0,1]
  v_pk_fma_f32 v[14:15], v[34:35], v[178:179], v[14:15]
  v_cvt_pk_bf16_f32 v32, v6, v10
  v_cvt_pk_bf16_f32 v33, v7, v11
  buffer_load_dwordx4 a[92:95], v243, s[64:67], s60 offen offset:3072 sc1
  v_cvt_pk_bf16_f32 v34, v12, v14
  v_cvt_pk_bf16_f32 v35, v13, v15
  s_nop 1
  v_mfma_f32_32x32x16_bf16 v[204:219], a[216:219], v[32:35], 0
  v_mfma_f32_32x32x16_bf16 v[16:31], a[232:235], v[32:35], 0
  v_pk_mul_f32 v[6:7], v[52:53], v[180:181]
  v_pk_mul_f32 v[10:11], v[52:53], v[164:165]
  v_pk_fma_f32 v[6:7], v[36:37], v[164:165], v[6:7] neg_lo:[0,0,1] neg_hi:[0,0,1]
  s_add_u32 s60, s60, 4096
  buffer_load_dwordx4 a[96:99], v243, s[64:67], s60 offen sc1
  v_pk_fma_f32 v[10:11], v[36:37], v[180:181], v[10:11]
  v_pk_mul_f32 v[12:13], v[54:55], v[182:183]
  v_pk_mul_f32 v[14:15], v[54:55], v[166:167]
  v_pk_fma_f32 v[12:13], v[38:39], v[166:167], v[12:13] neg_lo:[0,0,1] neg_hi:[0,0,1]
  v_pk_fma_f32 v[14:15], v[38:39], v[182:183], v[14:15]
  v_cvt_pk_bf16_f32 v36, v6, v10
  v_cvt_pk_bf16_f32 v37, v7, v11
  v_cvt_pk_bf16_f32 v38, v12, v14
  s_add_u32 s60, s61, 204800
  buffer_load_dwordx4 a[100:103], v243, s[64:67], s60 offen sc1
  v_cvt_pk_bf16_f32 v39, v13, v15
  s_nop 1
  v_mfma_f32_32x32x16_bf16 v[204:219], a[220:223], v[36:39], v[204:219]
  v_mfma_f32_32x32x16_bf16 v[16:31], a[236:239], v[36:39], v[16:31]
  v_pk_mul_f32 v[6:7], v[56:57], v[184:185]
  v_pk_mul_f32 v[10:11], v[56:57], v[168:169]
  v_pk_fma_f32 v[6:7], v[40:41], v[168:169], v[6:7] neg_lo:[0,0,1] neg_hi:[0,0,1]
  v_pk_fma_f32 v[10:11], v[40:41], v[184:185], v[10:11]
  buffer_load_dwordx4 a[104:107], v243, s[64:67], s60 offen offset:1024 sc1
  v_pk_mul_f32 v[12:13], v[58:59], v[186:187]
  v_pk_mul_f32 v[14:15], v[58:59], v[170:171]
  v_pk_fma_f32 v[12:13], v[42:43], v[170:171], v[12:13] neg_lo:[0,0,1] neg_hi:[0,0,1]
  v_pk_fma_f32 v[14:15], v[42:43], v[186:187], v[14:15]
  v_cvt_pk_bf16_f32 v40, v6, v10
  v_cvt_pk_bf16_f32 v41, v7, v11
  v_cvt_pk_bf16_f32 v42, v12, v14
  v_cvt_pk_bf16_f32 v43, v13, v15
  buffer_load_dwordx4 a[108:111], v243, s[64:67], s60 offen offset:2048 sc1
  s_nop 0
  v_mfma_f32_32x32x16_bf16 v[204:219], a[224:227], v[40:43], v[204:219]
  v_mfma_f32_32x32x16_bf16 v[16:31], a[240:243], v[40:43], v[16:31]
  v_pk_mul_f32 v[6:7], v[60:61], v[188:189]
  v_pk_mul_f32 v[10:11], v[60:61], v[172:173]
  v_pk_fma_f32 v[6:7], v[44:45], v[172:173], v[6:7] neg_lo:[0,0,1] neg_hi:[0,0,1]
  v_pk_fma_f32 v[10:11], v[44:45], v[188:189], v[10:11]
  v_pk_mul_f32 v[12:13], v[62:63], v[190:191]
  buffer_load_dwordx4 a[112:115], v243, s[64:67], s60 offen offset:3072 sc1
  v_pk_mul_f32 v[14:15], v[62:63], v[174:175]
  v_pk_fma_f32 v[12:13], v[46:47], v[174:175], v[12:13] neg_lo:[0,0,1] neg_hi:[0,0,1]
  v_pk_fma_f32 v[14:15], v[46:47], v[190:191], v[14:15]
  v_cvt_pk_bf16_f32 v44, v6, v10
  v_cvt_pk_bf16_f32 v45, v7, v11
  v_cvt_pk_bf16_f32 v46, v12, v14
  v_cvt_pk_bf16_f32 v47, v13, v15
  s_nop 1
  v_mfma_f32_32x32x16_bf16 v[204:219], a[228:231], v[44:47], v[204:219]
  s_add_u32 s60, s60, 4096
  buffer_load_dwordx4 a[116:119], v243, s[64:67], s60 offen sc1
  v_mfma_f32_32x32x16_bf16 v[16:31], a[244:247], v[44:47], v[16:31]
  v_lshlrev_b32 v4, 9, v3
  v_lshl_add_u32 v4, v2, 2, v4
  s_lshl_b32 s28, s20, 12
  s_add_u32 s28, s28, 139264
  v_add_u32 v4, s28, v4
  s_nop 6
  v_cvt_pk_bf16_f32 v32, v204, -v16
  s_add_u32 s60, s61, 245760
  buffer_load_dwordx4 a[120:123], v243, s[64:67], s60 offen sc1
  ds_write_b32 v4, v32 offset:0
  v_cvt_pk_bf16_f32 v33, v205, -v17
  ds_write_b32 v4, v33 offset:128
  v_cvt_pk_bf16_f32 v34, v206, -v18
  ds_write_b32 v4, v34 offset:256
  v_cvt_pk_bf16_f32 v35, v207, -v19
  ds_write_b32 v4, v35 offset:384
  v_cvt_pk_bf16_f32 v36, v208, -v20
  buffer_load_dwordx4 a[124:127], v243, s[64:67], s60 offen offset:1024 sc1
  ds_write_b32 v4, v36 offset:1024
  v_cvt_pk_bf16_f32 v37, v209, -v21
  ds_write_b32 v4, v37 offset:1152
  v_cvt_pk_bf16_f32 v38, v210, -v22
  ds_write_b32 v4, v38 offset:1280
  v_cvt_pk_bf16_f32 v39, v211, -v23
  ds_write_b32 v4, v39 offset:1408
  buffer_load_dwordx4 a[128:131], v243, s[64:67], s60 offen offset:2048 sc1
  v_cvt_pk_bf16_f32 v40, v212, -v24
  ds_write_b32 v4, v40 offset:2048
  v_cvt_pk_bf16_f32 v41, v213, -v25
  ds_write_b32 v4, v41 offset:2176
  v_cvt_pk_bf16_f32 v42, v214, -v26
  ds_write_b32 v4, v42 offset:2304
  v_cvt_pk_bf16_f32 v43, v215, -v27
  ds_write_b32 v4, v43 offset:2432
  buffer_load_dwordx4 a[132:135], v243, s[64:67], s60 offen offset:3072 sc1
  v_cvt_pk_bf16_f32 v44, v216, -v28
  ds_write_b32 v4, v44 offset:3072
  v_cvt_pk_bf16_f32 v45, v217, -v29
  ds_write_b32 v4, v45 offset:3200
  v_cvt_pk_bf16_f32 v46, v218, -v30
  ds_write_b32 v4, v46 offset:3328
  v_cvt_pk_bf16_f32 v47, v219, -v31
  s_add_u32 s60, s60, 4096
  buffer_load_dwordx4 a[136:139], v243, s[64:67], s60 offen sc1
  ds_write_b32 v4, v47 offset:3456
  s_lshl_b32 s29, s20, 10
  s_add_u32 s30, s29, 139264
  v_lshl_add_u32 v4, v1, 2, s30
  s_waitcnt lgkmcnt(0)
  s_barrier
  ds_read_b32 v16, v4 offset:0
  ds_read_b32 v17, v4 offset:4096
  ds_read_b32 v18, v4 offset:8192
  ds_read_b32 v19, v4 offset:12288
  ds_read_b32 v20, v4 offset:256
  ds_read_b32 v21, v4 offset:4352
  ds_read_b32 v22, v4 offset:8448
  ds_read_b32 v23, v4 offset:12544
  ds_read_b32 v24, v4 offset:512
  ds_read_b32 v25, v4 offset:4608
  ds_read_b32 v26, v4 offset:8704
  ds_read_b32 v27, v4 offset:12800
  ds_read_b32 v28, v4 offset:768
  ds_read_b32 v29, v4 offset:4864
  ds_read_b32 v30, v4 offset:8960
  ds_read_b32 v31, v4 offset:13056
  s_lshl_b32 s28, s63, 14
  s_lshl_b32 s29, s20, 12
  s_add_u32 s28, s28, s29
  v_lshlrev_b32 v5, 4, v1
  s_waitcnt lgkmcnt(12)
  buffer_store_dwordx4 v[16:19], v5, s[4:7], s28 offen offset:0 sc1
  s_waitcnt lgkmcnt(8)
  buffer_store_dwordx4 v[20:23], v5, s[4:7], s28 offen offset:1024 sc1
  s_waitcnt lgkmcnt(4)
  buffer_store_dwordx4 v[24:27], v5, s[4:7], s28 offen offset:2048 sc1
  s_waitcnt lgkmcnt(0)
  buffer_store_dwordx4 v[28:31], v5, s[4:7], s28 offen offset:3072 sc1
  s_branch K_a2d4
K_noa23:
  s_add_u32 s60, s61, 0
  buffer_load_dwordx4 a[0:3], v243, s[64:67], s60 offen sc1
  buffer_load_dwordx4 a[4:7], v243, s[64:67], s60 offen offset:1024 sc1
  buffer_load_dwordx4 a[8:11], v243, s[64:67], s60 offen offset:2048 sc1
  buffer_load_dwordx4 a[12:15], v243, s[64:67], s60 offen offset:3072 sc1
  s_add_u32 s60, s60, 4096
  buffer_load_dwordx4 a[16:19], v243, s[64:67], s60 offen sc1
  s_add_u32 s60, s61, 40960
  buffer_load_dwordx4 a[20:23], v243, s[64:67], s60 offen sc1
  buffer_load_dwordx4 a[24:27], v243, s[64:67], s60 offen offset:1024 sc1
  buffer_load_dwordx4 a[28:31], v243, s[64:67], s60 offen offset:2048 sc1
  buffer_load_dwordx4 a[32:35], v243, s[64:67], s60 offen offset:3072 sc1
  s_add_u32 s60, s60, 4096
  buffer_load_dwordx4 a[36:39], v243, s[64:67], s60 offen sc1
  s_add_u32 s60, s61, 81920
  buffer_load_dwordx4 a[40:43], v243, s[64:67], s60 offen sc1
  buffer_load_dwordx4 a[44:47], v243, s[64:67], s60 offen offset:1024 sc1
  buffer_load_dwordx4 a[48:51], v243, s[64:67], s60 offen offset:2048 sc1
  buffer_load_dwordx4 a[52:55], v243, s[64:67], s60 offen offset:3072 sc1
  s_add_u32 s60, s60, 4096
  buffer_load_dwordx4 a[56:59], v243, s[64:67], s60 offen sc1
  s_add_u32 s60, s61, 122880
  buffer_load_dwordx4 a[60:63], v243, s[64:67], s60 offen sc1
  buffer_load_dwordx4 a[64:67], v243, s[64:67], s60 offen offset:1024 sc1
  buffer_load_dwordx4 a[68:71], v243, s[64:67], s60 offen offset:2048 sc1
  buffer_load_dwordx4 a[72:75], v243, s[64:67], s60 offen offset:3072 sc1
  s_add_u32 s60, s60, 4096
  buffer_load_dwordx4 a[76:79], v243, s[64:67], s60 offen sc1
  s_add_u32 s60, s61, 163840
  buffer_load_dwordx4 a[80:83], v243, s[64:67], s60 offen sc1
  buffer_load_dwordx4 a[84:87], v243, s[64:67], s60 offen offset:1024 sc1
  buffer_load_dwordx4 a[88:91], v243, s[64:67], s60 offen offset:2048 sc1
  buffer_load_dwordx4 a[92:95], v243, s[64:67], s60 offen offset:3072 sc1
  s_add_u32 s60, s60, 4096
  buffer_load_dwordx4 a[96:99], v243, s[64:67], s60 offen sc1
  s_add_u32 s60, s61, 204800
  buffer_load_dwordx4 a[100:103], v243, s[64:67], s60 offen sc1
  buffer_load_dwordx4 a[104:107], v243, s[64:67], s60 offen offset:1024 sc1
  buffer_load_dwordx4 a[108:111], v243, s[64:67], s60 offen offset:2048 sc1
  buffer_load_dwordx4 a[112:115], v243, s[64:67], s60 offen offset:3072 sc1
  s_add_u32 s60, s60, 4096
  buffer_load_dwordx4 a[116:119], v243, s[64:67], s60 offen sc1
  s_add_u32 s60, s61, 245760
  buffer_load_dwordx4 a[120:123], v243, s[64:67], s60 offen sc1
  buffer_load_dwordx4 a[124:127], v243, s[64:67], s60 offen offset:1024 sc1
  buffer_load_dwordx4 a[128:131], v243, s[64:67], s60 offen offset:2048 sc1
  buffer_load_dwordx4 a[132:135], v243, s[64:67], s60 offen offset:3072 sc1
  s_add_u32 s60, s60, 4096
  buffer_load_dwordx4 a[136:139], v243, s[64:67], s60 offen sc1
K_a2d4:
  ds_read_b64_tr_b16 v[16:17], v241 offset:0
  ds_read_b64_tr_b16 v[18:19], v241 offset:768
  ds_read_b128 v[28:31], v237 offset:0
  ds_read_b128 v[32:35], v237 offset:4096
  ds_read_b64_tr_b16 v[20:21], v241 offset:32
  ds_read_b64_tr_b16 v[22:23], v241 offset:800
  ds_read_b64_tr_b16 v[24:25], v242 offset:64
  ds_read_b64_tr_b16 v[26:27], v242 offset:832
  s_waitcnt lgkmcnt(0)
  v_mfma_f32_32x32x16_bf16 v[64:79], v[16:19], v[28:31], v[64:79]
  ds_read_b64_tr_b16 v[36:37], v241 offset:3072
  ds_read_b64_tr_b16 v[38:39], v241 offset:3840
  ds_read_b128 v[48:51], v238 offset:0
  v_mfma_f32_32x32x16_bf16 v[80:95], v[16:19], v[32:35], v[80:95]
  ds_read_b128 v[52:55], v238 offset:4096
  ds_read_b64_tr_b16 v[40:41], v241 offset:3104
  ds_read_b64_tr_b16 v[42:43], v241 offset:3872
  s_add_u32 m0, s24, 61440
  s_mov_b32 s22, 1671168
  buffer_load_dwordx4 v236, s[12:15], s22 offen offset:2048 lds
  v_mfma_f32_32x32x16_bf16 v[96:111], v[20:23], v[28:31], v[96:111]
  ds_read_b64_tr_b16 v[44:45], v242 offset:3136
  ds_read_b64_tr_b16 v[46:47], v242 offset:3904
  v_mfma_f32_32x32x16_bf16 v[112:127], v[20:23], v[32:35], v[112:127]
  v_mfma_f32_32x32x16_bf16 v[128:143], v[24:27], v[28:31], v[128:143]
  v_mfma_f32_32x32x16_bf16 v[144:159], v[24:27], v[32:35], v[144:159]
  s_waitcnt vmcnt(45) lgkmcnt(0)
  s_barrier
  v_mfma_f32_32x32x16_bf16 v[64:79], v[36:39], v[48:51], v[64:79]
  ds_read_b64_tr_b16 v[16:17], v241 offset:12288
  ds_read_b64_tr_b16 v[18:19], v241 offset:13056
  ds_read_b128 v[28:31], v239 offset:0
  v_mfma_f32_32x32x16_bf16 v[80:95], v[36:39], v[52:55], v[80:95]
  ds_read_b128 v[32:35], v239 offset:4096
  ds_read_b64_tr_b16 v[20:21], v241 offset:12320
  ds_read_b64_tr_b16 v[22:23], v241 offset:13088
  s_add_u32 m0, s24, 0
  s_mov_b32 s22, 1769472
  buffer_load_dwordx4 v234, s[12:15], s22 offen lds
  v_mfma_f32_32x32x16_bf16 v[96:111], v[40:43], v[48:51], v[96:111]
  ds_read_b64_tr_b16 v[24:25], v242 offset:12352
  ds_read_b64_tr_b16 v[26:27], v242 offset:13120
  v_mfma_f32_32x32x16_bf16 v[112:127], v[40:43], v[52:55], v[112:127]
  s_add_u32 m0, s24, 0
  s_mov_b32 s22, 1769472
  buffer_load_dwordx4 v235, s[12:15], s22 offen offset:1024 lds
  v_mfma_f32_32x32x16_bf16 v[128:143], v[44:47], v[48:51], v[128:143]
  v_mfma_f32_32x32x16_bf16 v[144:159], v[44:47], v[52:55], v[144:159]
  s_add_u32 m0, s24, 0
  s_mov_b32 s22, 1769472
  buffer_load_dwordx4 v236, s[12:15], s22 offen offset:2048 lds
  s_waitcnt lgkmcnt(0)
  v_mfma_f32_32x32x16_bf16 v[64:79], v[16:19], v[28:31], v[64:79]
  ds_read_b64_tr_b16 v[36:37], v241 offset:15360
  ds_read_b64_tr_b16 v[38:39], v241 offset:16128
  ds_read_b128 v[48:51], v240 offset:0
  v_mfma_f32_32x32x16_bf16 v[80:95], v[16:19], v[32:35], v[80:95]
  ds_read_b128 v[52:55], v240 offset:4096
  ds_read_b64_tr_b16 v[40:41], v241 offset:15392
  ds_read_b64_tr_b16 v[42:43], v241 offset:16160
  v_mfma_f32_32x32x16_bf16 v[96:111], v[20:23], v[28:31], v[96:111]
  ds_read_b64_tr_b16 v[44:45], v242 offset:15424
  ds_read_b64_tr_b16 v[46:47], v242 offset:16192
  v_mfma_f32_32x32x16_bf16 v[112:127], v[20:23], v[32:35], v[112:127]
  v_mfma_f32_32x32x16_bf16 v[128:143], v[24:27], v[28:31], v[128:143]
  v_mfma_f32_32x32x16_bf16 v[144:159], v[24:27], v[32:35], v[144:159]
  s_waitcnt vmcnt(4) lgkmcnt(0)
  s_barrier
  v_mfma_f32_32x32x16_bf16 v[64:79], v[36:39], v[48:51], v[64:79]
  ds_read_b64_tr_b16 v[16:17], v241 offset:24576
  ds_read_b64_tr_b16 v[18:19], v241 offset:25344
  ds_read_b128 v[28:31], v237 offset:16384
  s_lshl_b32 s97, s98, 2
  s_add_u32 s97, s97, 40960
  s_cmp_eq_u32 s20, 0
  v_mfma_f32_32x32x16_bf16 v[80:95], v[36:39], v[52:55], v[80:95]
  ds_read_b128 v[32:35], v237 offset:20480
  ds_read_b64_tr_b16 v[20:21], v241 offset:24608
  ds_read_b64_tr_b16 v[22:23], v241 offset:25376
  s_cselect_b32 s97, s97, 0x40000000
  v_mov_b32 v249, s90
  v_and_b32 v254, 7, v0
  v_mfma_f32_32x32x16_bf16 v[96:111], v[40:43], v[48:51], v[96:111]
  ds_read_b64_tr_b16 v[24:25], v242 offset:24640
  ds_read_b64_tr_b16 v[26:27], v242 offset:25408
  v_lshlrev_b32 v254, 10, v254
  s_mov_b64 exec, 0xff
  buffer_store_dword v249, v254, s[92:95], s97 offen sc1
  s_mov_b64 exec, -1
  v_mfma_f32_32x32x16_bf16 v[112:127], v[40:43], v[52:55], v[112:127]
  v_mfma_f32_32x32x16_bf16 v[128:143], v[44:47], v[48:51], v[128:143]
  s_add_u32 m0, s23, 0
  s_mov_b32 s21, 1152
  buffer_load_dwordx4 v230, s[8:11], s21 offen lds
  v_mfma_f32_32x32x16_bf16 v[144:159], v[44:47], v[52:55], v[144:159]
  s_add_u32 m0, s23, 0
  s_mov_b32 s21, 1152
  buffer_load_dwordx4 v231, s[8:11], s21 offen offset:1024 lds
  s_waitcnt lgkmcnt(0)
  v_mfma_f32_32x32x16_bf16 v[64:79], v[16:19], v[28:31], v[64:79]
  ds_read_b64_tr_b16 v[36:37], v241 offset:27648
  ds_read_b64_tr_b16 v[38:39], v241 offset:28416
  ds_read_b128 v[48:51], v238 offset:16384
  s_add_u32 m0, s23, 0
  s_mov_b32 s21, 1152
  buffer_load_dwordx4 v232, s[8:11], s21 offen offset:2048 lds
  v_mfma_f32_32x32x16_bf16 v[80:95], v[16:19], v[32:35], v[80:95]
  ds_read_b128 v[52:55], v238 offset:20480
  ds_read_b64_tr_b16 v[40:41], v241 offset:27680
  ds_read_b64_tr_b16 v[42:43], v241 offset:28448
  s_add_u32 m0, s23, 0
  s_mov_b32 s21, 1152
  buffer_load_dwordx4 v233, s[8:11], s21 offen offset:3072 lds
  v_mfma_f32_32x32x16_bf16 v[96:111], v[20:23], v[28:31], v[96:111]
  ds_read_b64_tr_b16 v[44:45], v242 offset:27712
  ds_read_b64_tr_b16 v[46:47], v242 offset:28480
  s_add_u32 m0, s24, 12288
  s_mov_b32 s22, 1867776
  buffer_load_dwordx4 v234, s[12:15], s22 offen lds
  v_mfma_f32_32x32x16_bf16 v[112:127], v[20:23], v[32:35], v[112:127]
  s_add_u32 m0, s24, 12288
  s_mov_b32 s22, 1867776
  buffer_load_dwordx4 v235, s[12:15], s22 offen offset:1024 lds
  v_mfma_f32_32x32x16_bf16 v[128:143], v[24:27], v[28:31], v[128:143]
  s_add_u32 m0, s24, 12288
  s_mov_b32 s22, 1867776
  buffer_load_dwordx4 v236, s[12:15], s22 offen offset:2048 lds
  v_mfma_f32_32x32x16_bf16 v[144:159], v[24:27], v[32:35], v[144:159]
  s_waitcnt vmcnt(12) lgkmcnt(0)
  s_barrier
  v_mfma_f32_32x32x16_bf16 v[64:79], v[36:39], v[48:51], v[64:79]
  ds_read_b64_tr_b16 v[16:17], v241 offset:36864
  ds_read_b64_tr_b16 v[18:19], v241 offset:37632
  ds_read_b128 v[28:31], v239 offset:16384
  v_mfma_f32_32x32x16_bf16 v[80:95], v[36:39], v[52:55], v[80:95]
  ds_read_b128 v[32:35], v239 offset:20480
  ds_read_b64_tr_b16 v[20:21], v241 offset:36896
  ds_read_b64_tr_b16 v[22:23], v241 offset:37664
  v_mfma_f32_32x32x16_bf16 v[96:111], v[40:43], v[48:51], v[96:111]
  ds_read_b64_tr_b16 v[24:25], v242 offset:36928
  ds_read_b64_tr_b16 v[26:27], v242 offset:37696
  v_mfma_f32_32x32x16_bf16 v[112:127], v[40:43], v[52:55], v[112:127]
  v_mfma_f32_32x32x16_bf16 v[128:143], v[44:47], v[48:51], v[128:143]
  v_mfma_f32_32x32x16_bf16 v[144:159], v[44:47], v[52:55], v[144:159]
  s_waitcnt lgkmcnt(0)
  v_mfma_f32_32x32x16_bf16 v[64:79], v[16:19], v[28:31], v[64:79]
  ds_read_b64_tr_b16 v[36:37], v241 offset:39936
  ds_read_b64_tr_b16 v[38:39], v241 offset:40704
  ds_read_b128 v[48:51], v240 offset:16384
  v_mfma_f32_32x32x16_bf16 v[80:95], v[16:19], v[32:35], v[80:95]
  ds_read_b128 v[52:55], v240 offset:20480
  ds_read_b64_tr_b16 v[40:41], v241 offset:39968
  ds_read_b64_tr_b16 v[42:43], v241 offset:40736
  v_mfma_f32_32x32x16_bf16 v[96:111], v[20:23], v[28:31], v[96:111]
  ds_read_b64_tr_b16 v[44:45], v242 offset:40000
  ds_read_b64_tr_b16 v[46:47], v242 offset:40768
  v_mfma_f32_32x32x16_bf16 v[112:127], v[20:23], v[32:35], v[112:127]
  v_mfma_f32_32x32x16_bf16 v[128:143], v[24:27], v[28:31], v[128:143]
  v_mfma_f32_32x32x16_bf16 v[144:159], v[24:27], v[32:35], v[144:159]
  s_waitcnt vmcnt(12) lgkmcnt(0)
  s_barrier
  v_mfma_f32_32x32x16_bf16 v[64:79], v[36:39], v[48:51], v[64:79]
  ds_read_b64_tr_b16 v[16:17], v241 offset:49152
  ds_read_b64_tr_b16 v[18:19], v241 offset:49920
  ds_read_b128 v[28:31], v237 offset:32768
  v_mfma_f32_32x32x16_bf16 v[80:95], v[36:39], v[52:55], v[80:95]
  ds_read_b128 v[32:35], v237 offset:36864
  ds_read_b64_tr_b16 v[20:21], v241 offset:49184
  ds_read_b64_tr_b16 v[22:23], v241 offset:49952
  v_mfma_f32_32x32x16_bf16 v[96:111], v[40:43], v[48:51], v[96:111]
  ds_read_b64_tr_b16 v[24:25], v242 offset:49216
  ds_read_b64_tr_b16 v[26:27], v242 offset:49984
  v_mfma_f32_32x32x16_bf16 v[112:127], v[40:43], v[52:55], v[112:127]
  v_mfma_f32_32x32x16_bf16 v[128:143], v[44:47], v[48:51], v[128:143]
  v_mfma_f32_32x32x16_bf16 v[144:159], v[44:47], v[52:55], v[144:159]
  s_waitcnt lgkmcnt(0)
  v_mfma_f32_32x32x16_bf16 v[64:79], v[16:19], v[28:31], v[64:79]
  ds_read_b64_tr_b16 v[36:37], v241 offset:52224
  ds_read_b64_tr_b16 v[38:39], v241 offset:52992
  ds_read_b128 v[48:51], v238 offset:32768
  v_mfma_f32_32x32x16_bf16 v[80:95], v[16:19], v[32:35], v[80:95]
  ds_read_b128 v[52:55], v238 offset:36864
  ds_read_b64_tr_b16 v[40:41], v241 offset:52256
  ds_read_b64_tr_b16 v[42:43], v241 offset:53024
  v_mfma_f32_32x32x16_bf16 v[96:111], v[20:23], v[28:31], v[96:111]
  ds_read_b64_tr_b16 v[44:45], v242 offset:52288
  ds_read_b64_tr_b16 v[46:47], v242 offset:53056
  v_mfma_f32_32x32x16_bf16 v[112:127], v[20:23], v[32:35], v[112:127]
  v_mfma_f32_32x32x16_bf16 v[128:143], v[24:27], v[28:31], v[128:143]
  v_mfma_f32_32x32x16_bf16 v[144:159], v[24:27], v[32:35], v[144:159]
  s_waitcnt vmcnt(11) lgkmcnt(0)
  s_barrier
  v_mfma_f32_32x32x16_bf16 v[64:79], v[36:39], v[48:51], v[64:79]
  ds_read_b64_tr_b16 v[16:17], v241 offset:61440
  ds_read_b64_tr_b16 v[18:19], v241 offset:62208
  ds_read_b128 v[28:31], v239 offset:32768
  v_mfma_f32_32x32x16_bf16 v[80:95], v[36:39], v[52:55], v[80:95]
  ds_read_b128 v[32:35], v239 offset:36864
  ds_read_b64_tr_b16 v[20:21], v241 offset:61472
  ds_read_b64_tr_b16 v[22:23], v241 offset:62240
  v_mfma_f32_32x32x16_bf16 v[96:111], v[40:43], v[48:51], v[96:111]
  ds_read_b64_tr_b16 v[24:25], v242 offset:61504
  ds_read_b64_tr_b16 v[26:27], v242 offset:62272
  v_mfma_f32_32x32x16_bf16 v[112:127], v[40:43], v[52:55], v[112:127]
  v_mfma_f32_32x32x16_bf16 v[128:143], v[44:47], v[48:51], v[128:143]
  v_mfma_f32_32x32x16_bf16 v[144:159], v[44:47], v[52:55], v[144:159]
  s_waitcnt lgkmcnt(0)
  v_mfma_f32_32x32x16_bf16 v[64:79], v[16:19], v[28:31], v[64:79]
  ds_read_b64_tr_b16 v[36:37], v241 offset:64512
  ds_read_b64_tr_b16 v[38:39], v241 offset:65280
  ds_read_b128 v[48:51], v240 offset:32768
  v_mfma_f32_32x32x16_bf16 v[80:95], v[16:19], v[32:35], v[80:95]
  ds_read_b128 v[52:55], v240 offset:36864
  ds_read_b64_tr_b16 v[40:41], v241 offset:64544
  ds_read_b64_tr_b16 v[42:43], v241 offset:65312
  v_mfma_f32_32x32x16_bf16 v[96:111], v[20:23], v[28:31], v[96:111]
  ds_read_b64_tr_b16 v[44:45], v242 offset:64576
  ds_read_b64_tr_b16 v[46:47], v242 offset:65344
  v_mfma_f32_32x32x16_bf16 v[112:127], v[20:23], v[32:35], v[112:127]
  v_mfma_f32_32x32x16_bf16 v[128:143], v[24:27], v[28:31], v[128:143]
  v_mfma_f32_32x32x16_bf16 v[144:159], v[24:27], v[32:35], v[144:159]
  s_waitcnt vmcnt(3) lgkmcnt(0)
  s_barrier
  v_mfma_f32_32x32x16_bf16 v[64:79], v[36:39], v[48:51], v[64:79]
  ds_read_b64_tr_b16 v[16:17], v241 offset:0
  ds_read_b64_tr_b16 v[18:19], v241 offset:768
  ds_read_b128 v[28:31], v237 offset:0
  v_mfma_f32_32x32x16_bf16 v[80:95], v[36:39], v[52:55], v[80:95]
  ds_read_b128 v[32:35], v237 offset:4096
  ds_read_b64_tr_b16 v[20:21], v241 offset:32
  ds_read_b64_tr_b16 v[22:23], v241 offset:800
  v_mfma_f32_32x32x16_bf16 v[96:111], v[40:43], v[48:51], v[96:111]
  ds_read_b64_tr_b16 v[24:25], v242 offset:64
  ds_read_b64_tr_b16 v[26:27], v242 offset:832
  v_mfma_f32_32x32x16_bf16 v[112:127], v[40:43], v[52:55], v[112:127]
  v_mfma_f32_32x32x16_bf16 v[128:143], v[44:47], v[48:51], v[128:143]
  v_mfma_f32_32x32x16_bf16 v[144:159], v[44:47], v[52:55], v[144:159]
  s_waitcnt lgkmcnt(0)
  v_mfma_f32_32x32x16_bf16 v[64:79], v[16:19], v[28:31], v[64:79]
  ds_read_b64_tr_b16 v[36:37], v241 offset:3072
  ds_read_b64_tr_b16 v[38:39], v241 offset:3840
  ds_read_b128 v[48:51], v238 offset:0
  v_mfma_f32_32x32x16_bf16 v[80:95], v[16:19], v[32:35], v[80:95]
  ds_read_b128 v[52:55], v238 offset:4096
  ds_read_b64_tr_b16 v[40:41], v241 offset:3104
  ds_read_b64_tr_b16 v[42:43], v241 offset:3872
  v_mfma_f32_32x32x16_bf16 v[96:111], v[20:23], v[28:31], v[96:111]
  ds_read_b64_tr_b16 v[44:45], v242 offset:3136
  ds_read_b64_tr_b16 v[46:47], v242 offset:3904
  v_mfma_f32_32x32x16_bf16 v[112:127], v[20:23], v[32:35], v[112:127]
  v_mfma_f32_32x32x16_bf16 v[128:143], v[24:27], v[28:31], v[128:143]
  v_mfma_f32_32x32x16_bf16 v[144:159], v[24:27], v[32:35], v[144:159]
  s_waitcnt vmcnt(0) lgkmcnt(0)
  s_barrier
  v_mfma_f32_32x32x16_bf16 v[64:79], v[36:39], v[48:51], v[64:79]
  ds_read_b64_tr_b16 v[16:17], v241 offset:12288
  ds_read_b64_tr_b16 v[18:19], v241 offset:13056
  ds_read_b128 v[28:31], v239 offset:0
  v_mfma_f32_32x32x16_bf16 v[80:95], v[36:39], v[52:55], v[80:95]
  ds_read_b128 v[32:35], v239 offset:4096
  ds_read_b64_tr_b16 v[20:21], v241 offset:12320
  ds_read_b64_tr_b16 v[22:23], v241 offset:13088
  v_mfma_f32_32x32x16_bf16 v[96:111], v[40:43], v[48:51], v[96:111]
  ds_read_b64_tr_b16 v[24:25], v242 offset:12352
  ds_read_b64_tr_b16 v[26:27], v242 offset:13120
  v_mfma_f32_32x32x16_bf16 v[112:127], v[40:43], v[52:55], v[112:127]
  v_mfma_f32_32x32x16_bf16 v[128:143], v[44:47], v[48:51], v[128:143]
  v_mfma_f32_32x32x16_bf16 v[144:159], v[44:47], v[52:55], v[144:159]
  s_waitcnt lgkmcnt(0)
  v_mfma_f32_32x32x16_bf16 v[64:79], v[16:19], v[28:31], v[64:79]
  ds_read_b64_tr_b16 v[36:37], v241 offset:15360
  ds_read_b64_tr_b16 v[38:39], v241 offset:16128
  ds_read_b128 v[48:51], v240 offset:0
  v_mfma_f32_32x32x16_bf16 v[80:95], v[16:19], v[32:35], v[80:95]
  ds_read_b128 v[52:55], v240 offset:4096
  ds_read_b64_tr_b16 v[40:41], v241 offset:15392
  ds_read_b64_tr_b16 v[42:43], v241 offset:16160
  v_mfma_f32_32x32x16_bf16 v[96:111], v[20:23], v[28:31], v[96:111]
  ds_read_b64_tr_b16 v[44:45], v242 offset:15424
  ds_read_b64_tr_b16 v[46:47], v242 offset:16192
  v_mfma_f32_32x32x16_bf16 v[112:127], v[20:23], v[32:35], v[112:127]
  v_mfma_f32_32x32x16_bf16 v[128:143], v[24:27], v[28:31], v[128:143]
  v_mfma_f32_32x32x16_bf16 v[144:159], v[24:27], v[32:35], v[144:159]
  s_waitcnt lgkmcnt(0)
  v_mfma_f32_32x32x16_bf16 v[64:79], v[36:39], v[48:51], v[64:79]
  v_mfma_f32_32x32x16_bf16 v[80:95], v[36:39], v[52:55], v[80:95]
  v_mfma_f32_32x32x16_bf16 v[96:111], v[40:43], v[48:51], v[96:111]
  v_mfma_f32_32x32x16_bf16 v[112:127], v[40:43], v[52:55], v[112:127]
  v_mfma_f32_32x32x16_bf16 v[128:143], v[44:47], v[48:51], v[128:143]
  v_mfma_f32_32x32x16_bf16 v[144:159], v[44:47], v[52:55], v[144:159]
  s_and_b32 s28, s98, 7
  s_lshl_b32 s28, s28, 2
  s_lshr_b32 s29, s98, 3
  s_and_b32 s29, s29, 3
  s_add_u32 s21, s28, s29
  s_lshr_b32 s22, s98, 5
  s_add_u32 s16, s88, 0x100000
  s_addc_u32 s17, s89, 0
  s_and_b32 s17, s17, 0xffff
  s_mov_b32 s18, 0x600000
  s_mov_b32 s19, 0x20000
  s_lshr_b32 s28, s20, 1
  s_lshl_b32 s28, s28, 1
  s_lshl_b32 s29, s25, 2
  s_add_u32 s28, s28, s29
  s_mul_i32 s28, s28, 96
  s_mul_i32 s29, s26, 6
  s_add_u32 s28, s28, s29
  s_and_b32 s29, s20, 1
  s_mul_i32 s29, s29, 3
  s_add_u32 s28, s28, s29
  s_lshl_b32 s28, s28, 10
  v_and_b32 v56, 63, v0
  v_lshlrev_b32 v56, 4, v56
  s_mov_b32 s30, 0xbfb8aa3b
  s_mov_b32 s31, 0xbfb8aa3b
  s_nop 3
  v_pk_mul_f32 v[16:17], v[64:65], s[30:31]
  v_pk_mul_f32 v[18:19], v[66:67], s[30:31]
  v_pk_mul_f32 v[20:21], v[72:73], s[30:31]
  v_pk_mul_f32 v[22:23], v[74:75], s[30:31]
  v_exp_f32 v16, v16
  v_exp_f32 v17, v17
  v_exp_f32 v18, v18
  v_exp_f32 v19, v19
  v_exp_f32 v20, v20
  v_exp_f32 v21, v21
  v_exp_f32 v22, v22
  v_exp_f32 v23, v23
  v_pk_mul_f32 v[68:69], v[64:65], v[68:69]
  v_pk_mul_f32 v[70:71], v[66:67], v[70:71]
  v_pk_mul_f32 v[76:77], v[72:73], v[76:77]
  v_pk_mul_f32 v[78:79], v[74:75], v[78:79]
  v_pk_add_f32 v[16:17], v[16:17], 1.0 op_sel_hi:[1,0]
  v_pk_add_f32 v[18:19], v[18:19], 1.0 op_sel_hi:[1,0]
  v_pk_add_f32 v[20:21], v[20:21], 1.0 op_sel_hi:[1,0]
  v_pk_add_f32 v[22:23], v[22:23], 1.0 op_sel_hi:[1,0]
  v_rcp_f32 v16, v16
  v_rcp_f32 v17, v17
  v_rcp_f32 v18, v18
  v_rcp_f32 v19, v19
  v_rcp_f32 v20, v20
  v_rcp_f32 v21, v21
  v_rcp_f32 v22, v22
  v_rcp_f32 v23, v23
  s_nop 0
  v_pk_mul_f32 v[68:69], v[68:69], v[16:17]
  v_pk_mul_f32 v[70:71], v[70:71], v[18:19]
  v_pk_mul_f32 v[76:77], v[76:77], v[20:21]
  v_pk_mul_f32 v[78:79], v[78:79], v[22:23]
  v_cvt_pk_bf16_f32 v32, v68, v69
  v_cvt_pk_bf16_f32 v33, v70, v71
  v_cvt_pk_bf16_f32 v34, v76, v77
  v_cvt_pk_bf16_f32 v35, v78, v79
  s_add_u32 s29, s28, 0
  buffer_store_dwordx4 v[32:35], v56, s[16:19], s29 offen sc1
  v_pk_mul_f32 v[16:17], v[80:81], s[30:31]
  v_pk_mul_f32 v[18:19], v[82:83], s[30:31]
  v_pk_mul_f32 v[20:21], v[88:89], s[30:31]
  v_pk_mul_f32 v[22:23], v[90:91], s[30:31]
  v_exp_f32 v16, v16
  v_exp_f32 v17, v17
  v_exp_f32 v18, v18
  v_exp_f32 v19, v19
  v_exp_f32 v20, v20
  v_exp_f32 v21, v21
  v_exp_f32 v22, v22
  v_exp_f32 v23, v23
  v_pk_mul_f32 v[84:85], v[80:81], v[84:85]
  v_pk_mul_f32 v[86:87], v[82:83], v[86:87]
  v_pk_mul_f32 v[92:93], v[88:89], v[92:93]
  v_pk_mul_f32 v[94:95], v[90:91], v[94:95]
  v_pk_add_f32 v[16:17], v[16:17], 1.0 op_sel_hi:[1,0]
  v_pk_add_f32 v[18:19], v[18:19], 1.0 op_sel_hi:[1,0]
  v_pk_add_f32 v[20:21], v[20:21], 1.0 op_sel_hi:[1,0]
  v_pk_add_f32 v[22:23], v[22:23], 1.0 op_sel_hi:[1,0]
  v_rcp_f32 v16, v16
  v_rcp_f32 v17, v17
  v_rcp_f32 v18, v18
  v_rcp_f32 v19, v19
  v_rcp_f32 v20, v20
  v_rcp_f32 v21, v21
  v_rcp_f32 v22, v22
  v_rcp_f32 v23, v23
  s_nop 0
  v_pk_mul_f32 v[84:85], v[84:85], v[16:17]
  v_pk_mul_f32 v[86:87], v[86:87], v[18:19]
  v_pk_mul_f32 v[92:93], v[92:93], v[20:21]
  v_pk_mul_f32 v[94:95], v[94:95], v[22:23]
  v_cvt_pk_bf16_f32 v36, v84, v85
  v_cvt_pk_bf16_f32 v37, v86, v87
  v_cvt_pk_bf16_f32 v38, v92, v93
  v_cvt_pk_bf16_f32 v39, v94, v95
  s_add_u32 s29, s28, 98304
  buffer_store_dwordx4 v[36:39], v56, s[16:19], s29 offen sc1
  v_pk_mul_f32 v[16:17], v[96:97], s[30:31]
  v_pk_mul_f32 v[18:19], v[98:99], s[30:31]
  v_pk_mul_f32 v[20:21], v[104:105], s[30:31]
  v_pk_mul_f32 v[22:23], v[106:107], s[30:31]
  v_exp_f32 v16, v16
  v_exp_f32 v17, v17
  v_exp_f32 v18, v18
  v_exp_f32 v19, v19
  v_exp_f32 v20, v20
  v_exp_f32 v21, v21
  v_exp_f32 v22, v22
  v_exp_f32 v23, v23
  v_pk_mul_f32 v[100:101], v[96:97], v[100:101]
  v_pk_mul_f32 v[102:103], v[98:99], v[102:103]
  v_pk_mul_f32 v[108:109], v[104:105], v[108:109]
  v_pk_mul_f32 v[110:111], v[106:107], v[110:111]
  v_pk_add_f32 v[16:17], v[16:17], 1.0 op_sel_hi:[1,0]
  v_pk_add_f32 v[18:19], v[18:19], 1.0 op_sel_hi:[1,0]
  v_pk_add_f32 v[20:21], v[20:21], 1.0 op_sel_hi:[1,0]
  v_pk_add_f32 v[22:23], v[22:23], 1.0 op_sel_hi:[1,0]
  v_rcp_f32 v16, v16
  v_rcp_f32 v17, v17
  v_rcp_f32 v18, v18
  v_rcp_f32 v19, v19
  v_rcp_f32 v20, v20
  v_rcp_f32 v21, v21
  v_rcp_f32 v22, v22
  v_rcp_f32 v23, v23
  s_nop 0
  v_pk_mul_f32 v[100:101], v[100:101], v[16:17]
  v_pk_mul_f32 v[102:103], v[102:103], v[18:19]
  v_pk_mul_f32 v[108:109], v[108:109], v[20:21]
  v_pk_mul_f32 v[110:111], v[110:111], v[22:23]
  v_cvt_pk_bf16_f32 v32, v100, v101
  v_cvt_pk_bf16_f32 v33, v102, v103
  v_cvt_pk_bf16_f32 v34, v108, v109
  v_cvt_pk_bf16_f32 v35, v110, v111
  s_add_u32 s29, s28, 1024
  buffer_store_dwordx4 v[32:35], v56, s[16:19], s29 offen sc1
  v_pk_mul_f32 v[16:17], v[112:113], s[30:31]
  v_pk_mul_f32 v[18:19], v[114:115], s[30:31]
  v_pk_mul_f32 v[20:21], v[120:121], s[30:31]
  v_pk_mul_f32 v[22:23], v[122:123], s[30:31]
  v_exp_f32 v16, v16
  v_exp_f32 v17, v17
  v_exp_f32 v18, v18
  v_exp_f32 v19, v19
  v_exp_f32 v20, v20
  v_exp_f32 v21, v21
  v_exp_f32 v22, v22
  v_exp_f32 v23, v23
  v_pk_mul_f32 v[116:117], v[112:113], v[116:117]
  v_pk_mul_f32 v[118:119], v[114:115], v[118:119]
  v_pk_mul_f32 v[124:125], v[120:121], v[124:125]
  v_pk_mul_f32 v[126:127], v[122:123], v[126:127]
  v_pk_add_f32 v[16:17], v[16:17], 1.0 op_sel_hi:[1,0]
  v_pk_add_f32 v[18:19], v[18:19], 1.0 op_sel_hi:[1,0]
  v_pk_add_f32 v[20:21], v[20:21], 1.0 op_sel_hi:[1,0]
  v_pk_add_f32 v[22:23], v[22:23], 1.0 op_sel_hi:[1,0]
  v_rcp_f32 v16, v16
  v_rcp_f32 v17, v17
  v_rcp_f32 v18, v18
  v_rcp_f32 v19, v19
  v_rcp_f32 v20, v20
  v_rcp_f32 v21, v21
  v_rcp_f32 v22, v22
  v_rcp_f32 v23, v23
  s_nop 0
  v_pk_mul_f32 v[116:117], v[116:117], v[16:17]
  v_pk_mul_f32 v[118:119], v[118:119], v[18:19]
  v_pk_mul_f32 v[124:125], v[124:125], v[20:21]
  v_pk_mul_f32 v[126:127], v[126:127], v[22:23]
  v_cvt_pk_bf16_f32 v36, v116, v117
  v_cvt_pk_bf16_f32 v37, v118, v119
  v_cvt_pk_bf16_f32 v38, v124, v125
  v_cvt_pk_bf16_f32 v39, v126, v127
  s_add_u32 s29, s28, 99328
  buffer_store_dwordx4 v[36:39], v56, s[16:19], s29 offen sc1
  v_and_b32 v254, 63, v0
  v_lshlrev_b32 v254, 4, v254
  s_and_b32 s97, s98, 7
  s_lshl_b32 s97, s97, 10
  s_add_u32 s97, s97, 40960
  s_cmp_eq_u32 s20, 0
  s_cselect_b32 s97, s97, 0x40000000
  buffer_load_dwordx4 v[250:253], v254, s[92:95], s97 offen sc1
  v_pk_mul_f32 v[16:17], v[128:129], s[30:31]
  v_pk_mul_f32 v[18:19], v[130:131], s[30:31]
  v_pk_mul_f32 v[20:21], v[136:137], s[30:31]
  v_pk_mul_f32 v[22:23], v[138:139], s[30:31]
  v_exp_f32 v16, v16
  v_exp_f32 v17, v17
  v_exp_f32 v18, v18
  v_exp_f32 v19, v19
  v_exp_f32 v20, v20
  v_exp_f32 v21, v21
  v_exp_f32 v22, v22
  v_exp_f32 v23, v23
  v_pk_mul_f32 v[132:133], v[128:129], v[132:133]
  v_pk_mul_f32 v[134:135], v[130:131], v[134:135]
  v_pk_mul_f32 v[140:141], v[136:137], v[140:141]
  v_pk_mul_f32 v[142:143], v[138:139], v[142:143]
  v_pk_add_f32 v[16:17], v[16:17], 1.0 op_sel_hi:[1,0]
  v_pk_add_f32 v[18:19], v[18:19], 1.0 op_sel_hi:[1,0]
  v_pk_add_f32 v[20:21], v[20:21], 1.0 op_sel_hi:[1,0]
  v_pk_add_f32 v[22:23], v[22:23], 1.0 op_sel_hi:[1,0]
  v_rcp_f32 v16, v16
  v_rcp_f32 v17, v17
  v_rcp_f32 v18, v18
  v_rcp_f32 v19, v19
  v_rcp_f32 v20, v20
  v_rcp_f32 v21, v21
  v_rcp_f32 v22, v22
  v_rcp_f32 v23, v23
  s_nop 0
  v_pk_mul_f32 v[132:133], v[132:133], v[16:17]
  v_pk_mul_f32 v[134:135], v[134:135], v[18:19]
  v_pk_mul_f32 v[140:141], v[140:141], v[20:21]
  v_pk_mul_f32 v[142:143], v[142:143], v[22:23]
  v_cvt_pk_bf16_f32 v32, v132, v133
  v_cvt_pk_bf16_f32 v33, v134, v135
  v_cvt_pk_bf16_f32 v34, v140, v141
  v_cvt_pk_bf16_f32 v35, v142, v143
  s_add_u32 s29, s28, 2048
  buffer_store_dwordx4 v[32:35], v56, s[16:19], s29 offen sc1
  v_pk_mul_f32 v[16:17], v[144:145], s[30:31]
  v_pk_mul_f32 v[18:19], v[146:147], s[30:31]
  v_pk_mul_f32 v[20:21], v[152:153], s[30:31]
  v_pk_mul_f32 v[22:23], v[154:155], s[30:31]
  v_exp_f32 v16, v16
  v_exp_f32 v17, v17
  v_exp_f32 v18, v18
  v_exp_f32 v19, v19
  v_exp_f32 v20, v20
  v_exp_f32 v21, v21
  v_exp_f32 v22, v22
  v_exp_f32 v23, v23
  v_pk_mul_f32 v[148:149], v[144:145], v[148:149]
  v_pk_mul_f32 v[150:151], v[146:147], v[150:151]
  v_pk_mul_f32 v[156:157], v[152:153], v[156:157]
  v_pk_mul_f32 v[158:159], v[154:155], v[158:159]
  v_pk_add_f32 v[16:17], v[16:17], 1.0 op_sel_hi:[1,0]
  v_pk_add_f32 v[18:19], v[18:19], 1.0 op_sel_hi:[1,0]
  v_pk_add_f32 v[20:21], v[20:21], 1.0 op_sel_hi:[1,0]
  v_pk_add_f32 v[22:23], v[22:23], 1.0 op_sel_hi:[1,0]
  v_rcp_f32 v16, v16
  v_rcp_f32 v17, v17
  v_rcp_f32 v18, v18
  v_rcp_f32 v19, v19
  v_rcp_f32 v20, v20
  v_rcp_f32 v21, v21
  v_rcp_f32 v22, v22
  v_rcp_f32 v23, v23
  s_nop 0
  v_pk_mul_f32 v[148:149], v[148:149], v[16:17]
  v_pk_mul_f32 v[150:151], v[150:151], v[18:19]
  v_pk_mul_f32 v[156:157], v[156:157], v[20:21]
  v_pk_mul_f32 v[158:159], v[158:159], v[22:23]
  v_cvt_pk_bf16_f32 v36, v148, v149
  v_cvt_pk_bf16_f32 v37, v150, v151
  v_cvt_pk_bf16_f32 v38, v156, v157
  v_cvt_pk_bf16_f32 v39, v158, v159
  s_add_u32 s29, s28, 100352
  buffer_store_dwordx4 v[36:39], v56, s[16:19], s29 offen sc1
  s_lshl_b32 s97, s25, 1
  s_lshr_b32 s99, s20, 1
  s_add_u32 s97, s97, s99
  s_lshl_b32 s97, s97, 5
  s_lshl_b32 s99, s26, 1
  s_add_u32 s97, s97, s99
  s_and_b32 s99, s20, 1
  s_add_u32 s99, s97, s99
  v_and_b32 v1, 63, v0
  v_and_b32 v2, 31, v1
  v_lshrrev_b32 v3, 5, v1
  v_and_b32 v14, 3, v0
  v_mul_u32_u24 v15, 3104, v14
  v_add_u32 v15, 122880, v15
  s_mul_i32 s28, s20, 3104
  s_add_u32 s28, s28, 125440
  v_and_b32 v6, 7, v1
  v_lshl_add_u32 v6, v6, 2, s28
  v_mov_b32 v7, 0
  ds_write_b32 v6, v7
  s_lshl_b32 s28, s3, 2
  v_add_u32 v6, s28, v14
  v_cvt_f32_u32 v7, v6
  v_mul_f32 v7, 0x3a000000, v7
  v_cos_f32 v12, v7
  v_sin_f32 v13, v7
  v_lshrrev_b32 v7, 2, v0
  v_cvt_f32_u32 v9, v7
  v_add_f32 v10, 0x0, v9
  v_mul_f32 v10, 0x3acccccd, v10
  v_sin_f32 v64, -v10
  v_cos_f32 v65, v10
  v_add_u32 v8, 0, v7
  v_lshl_add_u32 v70, v8, 2, v15
  v_sub_u32 v8, 320, v8
  v_lshl_add_u32 v73, v8, 2, v15
  v_add_f32 v10, 0x42800000, v9
  v_mul_f32 v10, 0x3acccccd, v10
  v_sin_f32 v66, -v10
  v_cos_f32 v67, v10
  v_add_u32 v8, 64, v7
  v_lshl_add_u32 v71, v8, 2, v15
  v_sub_u32 v8, 320, v8
  v_lshl_add_u32 v74, v8, 2, v15
  v_add_f32 v10, 0x43000000, v9
  v_mul_f32 v10, 0x3acccccd, v10
  v_sin_f32 v68, -v10
  v_cos_f32 v69, v10
  v_add_u32 v8, 128, v7
  v_lshl_add_u32 v72, v8, 2, v15
  v_sub_u32 v8, 320, v8
  v_lshl_add_u32 v75, v8, 2, v15
  v_cmp_eq_u32 vcc, 0, v7
  s_nop 1
  v_cndmask_b32 v73, v73, v15, vcc
  v_mov_b32 v9, 135296
  v_cmp_lt_u32 vcc, 32, v7
  s_nop 1
  v_cndmask_b32 v72, v72, v9, vcc
  v_cndmask_b32 v75, v75, v9, vcc
  s_add_u32 s12, s88, 0x100000
  s_addc_u32 s13, s89, 0
  s_and_b32 s13, s13, 0xffff
  s_mov_b32 s14, 0x600000
  s_mov_b32 s15, 0x20000
  s_add_u32 s8, s88, 0x1800000
  s_addc_u32 s9, s89, 0
  s_and_b32 s9, s9, 0xffff
  s_mov_b32 s10, 0x280000
  s_mov_b32 s11, 0x20000
  s_mov_b32 s36, s84
  s_and_b32 s37, s85, 0xffff
  s_mov_b32 s38, 0x280000
  s_mov_b32 s39, 0x20000
  s_add_u32 s40, s88, 0x4000
  s_addc_u32 s41, s89, 0
  s_and_b32 s41, s41, 0xffff
  s_mov_b32 s42, 0x2000
  s_mov_b32 s43, 0x20000
  v_and_b32 v233, 63, v0
  v_and_b32 v234, 15, v233
  v_lshrrev_b32 v235, 4, v233
  v_lshl_add_u32 v236, v235, 5, v234
  v_lshlrev_b32 v230, 4, v236
  s_mul_i32 s28, s21, 196608
  s_mul_i32 s29, s20, 24576
  s_add_u32 s24, s28, s29
  s_add_u32 s28, s20, 0
  s_and_b32 s28, s28, 3
  s_lshr_b32 s29, s28, 1
  s_mul_i32 s29, s29, 98304
  s_and_b32 s28, s28, 1
  s_lshl_b32 s28, s28, 8
  s_add_u32 s28, s28, s29
  s_add_u32 s44, s28, s24
  s_add_u32 s28, s20, 1
  s_and_b32 s28, s28, 3
  s_lshr_b32 s29, s28, 1
  s_mul_i32 s29, s29, 98304
  s_and_b32 s28, s28, 1
  s_lshl_b32 s28, s28, 8
  s_add_u32 s28, s28, s29
  s_add_u32 s45, s28, s24
  s_add_u32 s28, s20, 2
  s_and_b32 s28, s28, 3
  s_lshr_b32 s29, s28, 1
  s_mul_i32 s29, s29, 98304
  s_and_b32 s28, s28, 1
  s_lshl_b32 s28, s28, 8
  s_add_u32 s28, s28, s29
  s_add_u32 s46, s28, s24
  s_add_u32 s28, s20, 3
  s_and_b32 s28, s28, 3
  s_lshr_b32 s29, s28, 1
  s_mul_i32 s29, s29, 98304
  s_and_b32 s28, s28, 1
  s_lshl_b32 s28, s28, 8
  s_add_u32 s28, s28, s29
  s_add_u32 s47, s28, s24
  s_lshl_b32 s28, s21, 6
  s_lshl_b32 s29, s20, 4
  s_add_u32 s28, s28, s29
  v_add_u32 v236, s28, v234
  v_lshlrev_b32 v232, 2, v236
  v_mul_u32_u24 v236, 1280, v236
  s_mul_i32 s28, s22, 160
  v_lshl_add_u32 v236, v235, 3, v236
  v_add_u32 v231, s28, v236
  s_waitcnt vmcnt(0)
  s_lshl_b32 s97, s99, 2
  s_add_u32 s97, s97, 4096
  v_mov_b32 v249, s90
  v_mov_b32 v254, 0
  s_mov_b64 exec, 1
  buffer_store_dword v249, v254, s[92:95], s97 offen sc1
  s_mov_b64 exec, -1
  s_waitcnt vmcnt(1)
  s_cmp_lg_u32 s20, 0
  s_cbranch_scc1 K_wok6
  s_mov_b32 s96, 0
K_w5:
  v_xor_b32 v250, s90, v250
  v_xor_b32 v251, s90, v251
  v_xor_b32 v252, s90, v252
  v_xor_b32 v253, s90, v253
  v_or3_b32 v250, v250, v251, v252
  v_or_b32 v250, v250, v253
  v_cmp_ne_u32 vcc, 0, v250
  s_cbranch_vccz K_wok6
  s_add_u32 s96, s96, 1
  s_cmp_gt_u32 s96, 20000
  s_cbranch_scc1 K_wok6
  v_and_b32 v254, 63, v0
  v_lshlrev_b32 v254, 4, v254
  s_and_b32 s97, s98, 7
  s_lshl_b32 s97, s97, 10
  s_add_u32 s97, s97, 40960
  s_sleep 2
  buffer_load_dwordx4 v[250:253], v254, s[92:95], s97 offen sc1
  s_waitcnt vmcnt(0)
  s_branch K_w5
K_wok6:
  s_barrier
  s_add_u32 s4, s88, 0x1000000
  s_addc_u32 s5, s89, 0
  s_and_b32 s5, s5, 0xffff
  s_mov_b32 s6, 0x288000
  s_mov_b32 s7, 0x20000
  v_lshrrev_b32 v4, 2, v0
  v_lshrrev_b32 v5, 1, v4
  v_lshlrev_b32 v5, 15, v5
  v_and_b32 v4, 1, v4
  v_lshl_add_u32 v5, v4, 3, v5
  v_and_b32 v4, 3, v0
  s_lshl_b32 s62, s3, 2
  v_add_u32 v4, s62, v4
  v_lshl_add_u32 v5, v4, 4, v5
  s_mov_b32 s62, 0
  buffer_load_dwordx2 v[204:205], v5, s[4:7], s62 offen sc1
  s_mov_b32 s62, 16384
  buffer_load_dwordx2 v[206:207], v5, s[4:7], s62 offen sc1
  s_mov_b32 s62, 1048576
  buffer_load_dwordx2 v[208:209], v5, s[4:7], s62 offen sc1
  s_mov_b32 s62, 1064960
  buffer_load_dwordx2 v[210:211], v5, s[4:7], s62 offen sc1
  s_mov_b32 s62, 2097152
  buffer_load_dwordx2 v[212:213], v5, s[4:7], s62 offen sc1
  s_mov_b32 s62, 2113536
  buffer_load_dwordx2 v[214:215], v5, s[4:7], s62 offen sc1
  s_add_u32 s60, s61, 286720
  buffer_load_dwordx4 a[140:143], v243, s[64:67], s60 offen sc1
  buffer_load_dwordx4 a[144:147], v243, s[64:67], s60 offen offset:1024 sc1
  buffer_load_dwordx4 a[148:151], v243, s[64:67], s60 offen offset:2048 sc1
  buffer_load_dwordx4 a[152:155], v243, s[64:67], s60 offen offset:3072 sc1
  s_add_u32 s60, s60, 4096
  buffer_load_dwordx4 a[156:159], v243, s[64:67], s60 offen sc1
  s_add_u32 s60, s61, 327680
  buffer_load_dwordx4 a[160:163], v243, s[64:67], s60 offen sc1
  v_lshrrev_b32 v7, 2, v0
  v_cmp_eq_u32 vcc, 0, v7
  s_waitcnt vmcnt(6)
  v_lshlrev_b32 v32, 16, v204
  v_and_b32 v33, 0xffff0000, v204
  v_lshlrev_b32 v34, 16, v205
  v_and_b32 v35, 0xffff0000, v205
  v_lshlrev_b32 v36, 16, v206
  v_and_b32 v37, 0xffff0000, v206
  v_lshlrev_b32 v38, 16, v207
  v_and_b32 v39, 0xffff0000, v207
  v_pk_mul_f32 v[60:61], v[36:37], v[12:13] op_sel:[1,1] op_sel_hi:[1,0]
  v_pk_mul_f32 v[62:63], v[38:39], v[12:13] op_sel:[1,1] op_sel_hi:[1,0]
  v_pk_fma_f32 v[36:37], v[36:37], v[12:13], v[60:61] op_sel:[0,0,0] op_sel_hi:[0,1,1] neg_lo:[0,0,1]
  v_pk_fma_f32 v[38:39], v[38:39], v[12:13], v[62:63] op_sel:[0,0,0] op_sel_hi:[0,1,1] neg_lo:[0,0,1]
  v_pk_add_f32 v[40:41], v[32:33], v[36:37]
  v_pk_add_f32 v[42:43], v[34:35], v[38:39]
  v_pk_add_f32 v[44:45], v[32:33], v[36:37] neg_lo:[0,1] neg_hi:[0,1]
  v_pk_add_f32 v[46:47], v[34:35], v[38:39] neg_lo:[0,1] neg_hi:[0,1]
  v_cndmask_b32_e64 v41, v41, 0, vcc
  v_cndmask_b32_e64 v43, v43, 0, vcc
  v_cndmask_b32_e64 v45, v45, 0, vcc
  v_cndmask_b32_e64 v47, v47, 0, vcc
  v_pk_add_f32 v[48:49], v[40:41], v[42:43] neg_hi:[0,1]
  v_pk_add_f32 v[52:53], v[40:41], v[42:43] neg_lo:[0,1]
  v_pk_add_f32 v[50:51], v[44:45], v[46:47] neg_hi:[0,1]
  v_pk_add_f32 v[54:55], v[44:45], v[46:47] neg_lo:[0,1]
  v_pk_mul_f32 v[56:57], v[52:53], v[64:65] op_sel:[1,1] op_sel_hi:[1,0]
  v_pk_mul_f32 v[58:59], v[54:55], v[64:65] op_sel:[1,1] op_sel_hi:[1,0]
  v_pk_fma_f32 v[56:57], v[52:53], v[64:65], v[56:57] op_sel:[0,0,0] op_sel_hi:[0,1,1] neg_lo:[0,0,1]
  v_pk_fma_f32 v[58:59], v[54:55], v[64:65], v[58:59] op_sel:[0,0,0] op_sel_hi:[0,1,1] neg_lo:[0,0,1]
  v_pk_add_f32 v[32:33], v[48:49], v[56:57] neg_hi:[1,1]
  v_pk_add_f32 v[34:35], v[48:49], v[56:57] neg_lo:[0,1] neg_hi:[0,1]
  v_pk_add_f32 v[36:37], v[50:51], v[58:59] neg_hi:[1,1]
  v_pk_add_f32 v[38:39], v[50:51], v[58:59] neg_lo:[0,1] neg_hi:[0,1]
  v_cvt_pk_bf16_f32 v60, v32, v33
  v_cvt_pk_bf16_f32 v61, v34, v35
  v_cvt_pk_bf16_f32 v62, v36, v37
  v_cvt_pk_bf16_f32 v63, v38, v39
  ds_write_b32 v70, v60
  ds_write_b32 v73, v61
  ds_write_b32 v70, v62 offset:1280
  ds_write_b32 v73, v63 offset:1280
  buffer_load_dwordx4 a[164:167], v243, s[64:67], s60 offen offset:1024 sc1
  buffer_load_dwordx4 a[168:171], v243, s[64:67], s60 offen offset:2048 sc1
  buffer_load_dwordx4 a[172:175], v243, s[64:67], s60 offen offset:3072 sc1
  s_add_u32 s60, s60, 4096
  buffer_load_dwordx4 a[176:179], v243, s[64:67], s60 offen sc1
  v_lshlrev_b32 v32, 16, v208
  v_and_b32 v33, 0xffff0000, v208
  v_lshlrev_b32 v34, 16, v209
  v_and_b32 v35, 0xffff0000, v209
  v_lshlrev_b32 v36, 16, v210
  v_and_b32 v37, 0xffff0000, v210
  v_lshlrev_b32 v38, 16, v211
  v_and_b32 v39, 0xffff0000, v211
  v_pk_mul_f32 v[60:61], v[36:37], v[12:13] op_sel:[1,1] op_sel_hi:[1,0]
  v_pk_mul_f32 v[62:63], v[38:39], v[12:13] op_sel:[1,1] op_sel_hi:[1,0]
  v_pk_fma_f32 v[36:37], v[36:37], v[12:13], v[60:61] op_sel:[0,0,0] op_sel_hi:[0,1,1] neg_lo:[0,0,1]
  v_pk_fma_f32 v[38:39], v[38:39], v[12:13], v[62:63] op_sel:[0,0,0] op_sel_hi:[0,1,1] neg_lo:[0,0,1]
  v_pk_add_f32 v[40:41], v[32:33], v[36:37]
  v_pk_add_f32 v[42:43], v[34:35], v[38:39]
  v_pk_add_f32 v[44:45], v[32:33], v[36:37] neg_lo:[0,1] neg_hi:[0,1]
  v_pk_add_f32 v[46:47], v[34:35], v[38:39] neg_lo:[0,1] neg_hi:[0,1]
  v_pk_add_f32 v[48:49], v[40:41], v[42:43] neg_hi:[0,1]
  v_pk_add_f32 v[52:53], v[40:41], v[42:43] neg_lo:[0,1]
  v_pk_add_f32 v[50:51], v[44:45], v[46:47] neg_hi:[0,1]
  v_pk_add_f32 v[54:55], v[44:45], v[46:47] neg_lo:[0,1]
  v_pk_mul_f32 v[56:57], v[52:53], v[66:67] op_sel:[1,1] op_sel_hi:[1,0]
  v_pk_mul_f32 v[58:59], v[54:55], v[66:67] op_sel:[1,1] op_sel_hi:[1,0]
  v_pk_fma_f32 v[56:57], v[52:53], v[66:67], v[56:57] op_sel:[0,0,0] op_sel_hi:[0,1,1] neg_lo:[0,0,1]
  v_pk_fma_f32 v[58:59], v[54:55], v[66:67], v[58:59] op_sel:[0,0,0] op_sel_hi:[0,1,1] neg_lo:[0,0,1]
  v_pk_add_f32 v[32:33], v[48:49], v[56:57] neg_hi:[1,1]
  v_pk_add_f32 v[34:35], v[48:49], v[56:57] neg_lo:[0,1] neg_hi:[0,1]
  v_pk_add_f32 v[36:37], v[50:51], v[58:59] neg_hi:[1,1]
  v_pk_add_f32 v[38:39], v[50:51], v[58:59] neg_lo:[0,1] neg_hi:[0,1]
  v_cvt_pk_bf16_f32 v60, v32, v33
  v_cvt_pk_bf16_f32 v61, v34, v35
  v_cvt_pk_bf16_f32 v62, v36, v37
  v_cvt_pk_bf16_f32 v63, v38, v39
  ds_write_b32 v71, v60
  ds_write_b32 v74, v61
  ds_write_b32 v71, v62 offset:1280
  ds_write_b32 v74, v63 offset:1280
  s_add_u32 s60, s61, 368640
  buffer_load_dwordx4 a[180:183], v243, s[64:67], s60 offen sc1
  buffer_load_dwordx4 a[184:187], v243, s[64:67], s60 offen offset:1024 sc1
  buffer_load_dwordx4 a[188:191], v243, s[64:67], s60 offen offset:2048 sc1
  buffer_load_dwordx4 a[192:195], v243, s[64:67], s60 offen offset:3072 sc1
  v_lshlrev_b32 v32, 16, v212
  v_and_b32 v33, 0xffff0000, v212
  v_lshlrev_b32 v34, 16, v213
  v_and_b32 v35, 0xffff0000, v213
  v_lshlrev_b32 v36, 16, v214
  v_and_b32 v37, 0xffff0000, v214
  v_lshlrev_b32 v38, 16, v215
  v_and_b32 v39, 0xffff0000, v215
  v_pk_mul_f32 v[60:61], v[36:37], v[12:13] op_sel:[1,1] op_sel_hi:[1,0]
  v_pk_mul_f32 v[62:63], v[38:39], v[12:13] op_sel:[1,1] op_sel_hi:[1,0]
  v_pk_fma_f32 v[36:37], v[36:37], v[12:13], v[60:61] op_sel:[0,0,0] op_sel_hi:[0,1,1] neg_lo:[0,0,1]
  v_pk_fma_f32 v[38:39], v[38:39], v[12:13], v[62:63] op_sel:[0,0,0] op_sel_hi:[0,1,1] neg_lo:[0,0,1]
  v_pk_add_f32 v[40:41], v[32:33], v[36:37]
  v_pk_add_f32 v[42:43], v[34:35], v[38:39]
  v_pk_add_f32 v[44:45], v[32:33], v[36:37] neg_lo:[0,1] neg_hi:[0,1]
  v_pk_add_f32 v[46:47], v[34:35], v[38:39] neg_lo:[0,1] neg_hi:[0,1]
  v_pk_add_f32 v[48:49], v[40:41], v[42:43] neg_hi:[0,1]
  v_pk_add_f32 v[52:53], v[40:41], v[42:43] neg_lo:[0,1]
  v_pk_add_f32 v[50:51], v[44:45], v[46:47] neg_hi:[0,1]
  v_pk_add_f32 v[54:55], v[44:45], v[46:47] neg_lo:[0,1]
  v_pk_mul_f32 v[56:57], v[52:53], v[68:69] op_sel:[1,1] op_sel_hi:[1,0]
  v_pk_mul_f32 v[58:59], v[54:55], v[68:69] op_sel:[1,1] op_sel_hi:[1,0]
  v_pk_fma_f32 v[56:57], v[52:53], v[68:69], v[56:57] op_sel:[0,0,0] op_sel_hi:[0,1,1] neg_lo:[0,0,1]
  v_pk_fma_f32 v[58:59], v[54:55], v[68:69], v[58:59] op_sel:[0,0,0] op_sel_hi:[0,1,1] neg_lo:[0,0,1]
  v_pk_add_f32 v[32:33], v[48:49], v[56:57] neg_hi:[1,1]
  v_pk_add_f32 v[34:35], v[48:49], v[56:57] neg_lo:[0,1] neg_hi:[0,1]
  v_pk_add_f32 v[36:37], v[50:51], v[58:59] neg_hi:[1,1]
  v_pk_add_f32 v[38:39], v[50:51], v[58:59] neg_lo:[0,1] neg_hi:[0,1]
  v_cvt_pk_bf16_f32 v60, v32, v33
  v_cvt_pk_bf16_f32 v61, v34, v35
  v_cvt_pk_bf16_f32 v62, v36, v37
  v_cvt_pk_bf16_f32 v63, v38, v39
  ds_write_b32 v72, v60
  ds_write_b32 v75, v61
  ds_write_b32 v72, v62 offset:1280
  ds_write_b32 v75, v63 offset:1280
  s_waitcnt lgkmcnt(0)
  s_add_u32 s60, s60, 4096
  buffer_load_dwordx4 a[196:199], v243, s[64:67], s60 offen sc1
  s_barrier
  v_and_b32 v254, 31, v0
  s_lshl_b32 s97, s21, 5
  v_add_u32 v254, s97, v254
  v_lshlrev_b32 v254, 2, v254
  s_mov_b32 s97, 4096
  buffer_load_dword v250, v254, s[92:95], s97 offen sc1
  v_bfe_u32 v4, v1, 4, 1
  v_mul_u32_u24 v4, 1280, v4
  v_and_b32 v5, 15, v1
  v_lshl_add_u32 v4, v5, 2, v4
  v_mul_u32_u24 v5, 160, v3
  s_mul_i32 s28, s20, 3104
  s_add_u32 s28, s28, 122880
  v_add3_u32 v4, v4, v5, s28
  ds_read_b32 v16, v4 offset:0
  ds_read_b32 v17, v4 offset:40
  ds_read_b32 v18, v4 offset:80
  ds_read_b32 v19, v4 offset:120
  ds_read_b32 v20, v4 offset:320
  ds_read_b32 v21, v4 offset:360
  ds_read_b32 v22, v4 offset:400
  ds_read_b32 v23, v4 offset:440
  ds_read_b32 v24, v4 offset:640
  ds_read_b32 v25, v4 offset:680
  ds_read_b32 v26, v4 offset:720
  ds_read_b32 v27, v4 offset:760
  ds_read_b32 v28, v4 offset:960
  ds_read_b32 v29, v4 offset:1000
  ds_read_b32 v30, v4 offset:1040
  ds_read_b32 v31, v4 offset:1080
  v_mov_b32 v6, 0x34cccccd
  v_mul_f32 v8, s27, v6
  v_mul_f32 v10, s91, v6
  v_sub_f32 v9, 0, v8
  v_sub_f32 v11, 0, v10
  s_waitcnt lgkmcnt(0)
  v_mfma_f32_32x32x16_bf16 v[32:47], v[16:19], a[216:219], 0
  v_mfma_f32_32x32x16_bf16 v[48:63], v[16:19], a[232:235], 0
  v_mfma_f32_32x32x16_bf16 v[32:47], v[20:23], a[220:223], v[32:47]
  v_mfma_f32_32x32x16_bf16 v[48:63], v[20:23], a[236:239], v[48:63]
  v_mfma_f32_32x32x16_bf16 v[32:47], v[24:27], a[224:227], v[32:47]
  v_mfma_f32_32x32x16_bf16 v[48:63], v[24:27], a[240:243], v[48:63]
  v_mfma_f32_32x32x16_bf16 v[32:47], v[28:31], a[228:231], v[32:47]
  v_mfma_f32_32x32x16_bf16 v[48:63], v[28:31], a[244:247], v[48:63]
  v_mov_b32 v102, 0
  v_mov_b32 v103, 0
  v_mov_b32 v110, 0
  v_mov_b32 v111, 0
  s_waitcnt vmcnt(0)
  s_mov_b32 s96, 0
K_w7:
  v_cmp_ne_u32 vcc, s90, v250
  s_cbranch_vccz K_wok8
  s_add_u32 s96, s96, 1
  s_cmp_gt_u32 s96, 20000
  s_cbranch_scc1 K_wok8
  s_mov_b32 s97, 4096
  s_sleep 4
  buffer_load_dword v250, v254, s[92:95], s97 offen sc1
  s_waitcnt vmcnt(0)
  s_branch K_w7
K_wok8:
  s_add_u32 s30, s44, 0
  buffer_load_dwordx4 v[144:147], v230, s[12:15], s30 offen sc1
  s_add_u32 s30, s45, 0
  buffer_load_dwordx4 v[148:151], v230, s[12:15], s30 offen sc1
  s_add_u32 s30, s46, 0
  buffer_load_dwordx4 v[152:155], v230, s[12:15], s30 offen sc1
  s_add_u32 s30, s47, 0
  buffer_load_dwordx4 v[156:159], v230, s[12:15], s30 offen sc1
  s_add_u32 s30, s44, 2048
  buffer_load_dwordx4 v[160:163], v230, s[12:15], s30 offen sc1
  s_add_u32 s30, s45, 2048
  buffer_load_dwordx4 v[164:167], v230, s[12:15], s30 offen sc1
  s_add_u32 s30, s46, 2048
  buffer_load_dwordx4 v[168:171], v230, s[12:15], s30 offen sc1
  s_add_u32 s30, s47, 2048
  buffer_load_dwordx4 v[172:175], v230, s[12:15], s30 offen sc1
  s_add_u32 s30, s44, 4096
  buffer_load_dwordx4 v[176:179], v230, s[12:15], s30 offen sc1
  s_add_u32 s30, s45, 4096
  buffer_load_dwordx4 v[180:183], v230, s[12:15], s30 offen sc1
  s_add_u32 s30, s46, 4096
  buffer_load_dwordx4 v[184:187], v230, s[12:15], s30 offen sc1
  s_add_u32 s30, s47, 4096
  buffer_load_dwordx4 v[188:191], v230, s[12:15], s30 offen sc1
  v_pk_mul_f32 v[12:13], v[48:49], v[198:199]
  v_pk_mul_f32 v[14:15], v[48:49], v[192:193]
  v_pk_fma_f32 v[12:13], v[32:33], v[192:193], v[12:13] neg_lo:[0,0,1] neg_hi:[0,0,1]
  v_pk_fma_f32 v[14:15], v[32:33], v[198:199], v[14:15]
  v_cvt_pk_bf16_f32 v96, v12, v14
  v_cvt_pk_bf16_f32 v97, v13, v15
  v_pk_mul_f32 v[12:13], v[50:51], v[200:201]
  v_pk_mul_f32 v[14:15], v[50:51], v[194:195]
  v_pk_fma_f32 v[12:13], v[34:35], v[194:195], v[12:13] neg_lo:[0,0,1] neg_hi:[0,0,1]
  v_pk_fma_f32 v[14:15], v[34:35], v[200:201], v[14:15]
  v_cvt_pk_bf16_f32 v98, v12, v14
  v_cvt_pk_bf16_f32 v99, v13, v15
  v_pk_mul_f32 v[12:13], v[52:53], v[202:203]
  v_pk_mul_f32 v[14:15], v[52:53], v[196:197]
  v_pk_fma_f32 v[12:13], v[36:37], v[196:197], v[12:13] neg_lo:[0,0,1] neg_hi:[0,0,1]
  v_pk_fma_f32 v[14:15], v[36:37], v[202:203], v[14:15]
  v_cvt_pk_bf16_f32 v100, v12, v14
  v_cvt_pk_bf16_f32 v101, v13, v15
  v_pk_mul_f32 v[12:13], v[56:57], v[198:199]
  v_pk_mul_f32 v[14:15], v[56:57], v[192:193]
  v_pk_fma_f32 v[12:13], v[40:41], v[192:193], v[12:13] neg_lo:[0,0,1] neg_hi:[0,0,1]
  v_pk_fma_f32 v[14:15], v[40:41], v[198:199], v[14:15]
  v_cvt_pk_bf16_f32 v104, v12, v14
  v_cvt_pk_bf16_f32 v105, v13, v15
  v_pk_mul_f32 v[12:13], v[58:59], v[200:201]
  v_pk_mul_f32 v[14:15], v[58:59], v[194:195]
  v_pk_fma_f32 v[12:13], v[42:43], v[194:195], v[12:13] neg_lo:[0,0,1] neg_hi:[0,0,1]
  v_pk_fma_f32 v[14:15], v[42:43], v[200:201], v[14:15]
  v_cvt_pk_bf16_f32 v106, v12, v14
  v_cvt_pk_bf16_f32 v107, v13, v15
  v_pk_mul_f32 v[12:13], v[60:61], v[202:203]
  v_pk_mul_f32 v[14:15], v[60:61], v[196:197]
  v_pk_fma_f32 v[12:13], v[44:45], v[196:197], v[12:13] neg_lo:[0,0,1] neg_hi:[0,0,1]
  v_pk_fma_f32 v[14:15], v[44:45], v[202:203], v[14:15]
  v_cvt_pk_bf16_f32 v108, v12, v14
  v_cvt_pk_bf16_f32 v109, v13, v15
  v_mfma_f32_32x32x16_bf16 v[32:47], a[248:251], v[96:99], 0
  v_mfma_f32_32x32x16_bf16 v[32:47], a[252:255], v[100:103], v[32:47]
  v_mfma_f32_32x32x16_bf16 v[48:63], a[248:251], v[104:107], 0
  v_mfma_f32_32x32x16_bf16 v[48:63], a[252:255], v[108:111], v[48:63]
  s_mul_i32 s28, s20, 2560
  s_add_u32 s28, s28, 135680
  v_lshl_add_u32 v4, v3, 6, v2
  v_lshl_add_u32 v4, v4, 2, s28
  s_nop 5
  v_pk_mul_f32 v[32:33], v[32:33], v[8:9]
  v_cvt_pk_bf16_f32 v32, v32, v33
  ds_write_b32 v4, v32 offset:0
  v_pk_mul_f32 v[34:35], v[34:35], v[8:9]
  v_cvt_pk_bf16_f32 v34, v34, v35
  ds_write_b32 v4, v34 offset:128
  v_pk_mul_f32 v[48:49], v[48:49], v[10:11]
  v_cvt_pk_bf16_f32 v48, v48, v49
  ds_write_b32 v4, v48 offset:1280
  v_pk_mul_f32 v[50:51], v[50:51], v[10:11]
  v_cvt_pk_bf16_f32 v50, v50, v51
  ds_write_b32 v4, v50 offset:1408
  v_pk_mul_f32 v[36:37], v[36:37], v[8:9]
  v_cvt_pk_bf16_f32 v36, v36, v37
  ds_write_b32 v4, v36 offset:512
  v_pk_mul_f32 v[38:39], v[38:39], v[8:9]
  v_cvt_pk_bf16_f32 v38, v38, v39
  ds_write_b32 v4, v38 offset:640
  v_pk_mul_f32 v[52:53], v[52:53], v[10:11]
  v_cvt_pk_bf16_f32 v52, v52, v53
  ds_write_b32 v4, v52 offset:1792
  v_pk_mul_f32 v[54:55], v[54:55], v[10:11]
  v_cvt_pk_bf16_f32 v54, v54, v55
  ds_write_b32 v4, v54 offset:1920
  s_mov_b64 exec, 0xffffffff
  v_pk_mul_f32 v[40:41], v[40:41], v[8:9]
  v_cvt_pk_bf16_f32 v40, v40, v41
  ds_write_b32 v4, v40 offset:1024
  v_pk_mul_f32 v[42:43], v[42:43], v[8:9]
  v_cvt_pk_bf16_f32 v42, v42, v43
  ds_write_b32 v4, v42 offset:1152
  v_pk_mul_f32 v[56:57], v[56:57], v[10:11]
  v_cvt_pk_bf16_f32 v56, v56, v57
  ds_write_b32 v4, v56 offset:2304
  v_pk_mul_f32 v[58:59], v[58:59], v[10:11]
  v_cvt_pk_bf16_f32 v58, v58, v59
  ds_write_b32 v4, v58 offset:2432
  s_mov_b64 exec, -1
  s_add_u32 s4, s88, 0x1800000
  s_addc_u32 s5, s89, 0
  s_and_b32 s5, s5, 0xffff
  s_mov_b32 s6, 0x280000
  s_mov_b32 s7, 0x20000
  v_lshl_add_u32 v4, v1, 4, s28
  s_waitcnt lgkmcnt(0)
  ds_read_b128 v[16:19], v4 offset:0
  ds_read_b128 v[20:23], v4 offset:1024
  ds_read_b128 v[24:27], v4 offset:2048
  s_lshl_b32 s28, s3, 2
  s_add_u32 s28, s28, s20
  s_mul_i32 s28, s28, 1280
  v_lshlrev_b32 v4, 4, v1
  v_add_u32 v5, 1024, v4
  v_add_u32 v6, 1310464, v4
  v_cmp_gt_u32 vcc, 16, v1
  s_nop 1
  v_cndmask_b32 v5, v6, v5, vcc
  v_add_u32 v7, 1311488, v4
  v_mov_b32 v6, 0x40000000
  v_cmp_gt_u32 vcc, 32, v1
  s_nop 1
  v_cndmask_b32 v7, v6, v7, vcc
  s_waitcnt lgkmcnt(0)
  buffer_store_dwordx4 v[16:19], v4, s[4:7], s28 offen sc1
  buffer_store_dwordx4 v[20:23], v5, s[4:7], s28 offen sc1
  buffer_store_dwordx4 v[24:27], v7, s[4:7], s28 offen sc1
  s_add_u32 s30, s44, 6144
  buffer_load_dwordx4 v[16:19], v230, s[12:15], s30 offen sc1
  s_add_u32 s30, s45, 6144
  buffer_load_dwordx4 v[20:23], v230, s[12:15], s30 offen sc1
  s_add_u32 s30, s46, 6144
  buffer_load_dwordx4 v[24:27], v230, s[12:15], s30 offen sc1
  s_add_u32 s30, s47, 6144
  buffer_load_dwordx4 v[28:31], v230, s[12:15], s30 offen sc1
  s_waitcnt vmcnt(15)
  v_mfma_f32_16x16x32_bf16 v[64:67], a[0:3], v[144:147], 0
  v_mfma_f32_16x16x32_bf16 v[84:87], a[0:3], v[148:151], 0
  s_add_u32 s30, s44, 8192
  buffer_load_dwordx4 v[32:35], v230, s[12:15], s30 offen sc1
  v_mfma_f32_16x16x32_bf16 v[104:107], a[0:3], v[152:155], 0
  v_mfma_f32_16x16x32_bf16 v[124:127], a[0:3], v[156:159], 0
  v_mfma_f32_16x16x32_bf16 v[68:71], a[4:7], v[144:147], 0
  v_mfma_f32_16x16x32_bf16 v[88:91], a[4:7], v[148:151], 0
  v_mfma_f32_16x16x32_bf16 v[108:111], a[4:7], v[152:155], 0
  s_add_u32 s30, s45, 8192
  buffer_load_dwordx4 v[36:39], v230, s[12:15], s30 offen sc1
  v_mfma_f32_16x16x32_bf16 v[128:131], a[4:7], v[156:159], 0
  v_mfma_f32_16x16x32_bf16 v[72:75], a[8:11], v[144:147], 0
  v_mfma_f32_16x16x32_bf16 v[92:95], a[8:11], v[148:151], 0
  v_mfma_f32_16x16x32_bf16 v[112:115], a[8:11], v[152:155], 0
  v_mfma_f32_16x16x32_bf16 v[132:135], a[8:11], v[156:159], 0
  s_add_u32 s30, s46, 8192
  buffer_load_dwordx4 v[40:43], v230, s[12:15], s30 offen sc1
  v_mfma_f32_16x16x32_bf16 v[76:79], a[12:15], v[144:147], 0
  v_mfma_f32_16x16x32_bf16 v[96:99], a[12:15], v[148:151], 0
  v_mfma_f32_16x16x32_bf16 v[116:119], a[12:15], v[152:155], 0
  v_mfma_f32_16x16x32_bf16 v[136:139], a[12:15], v[156:159], 0
  v_mfma_f32_16x16x32_bf16 v[80:83], a[16:19], v[144:147], 0
  s_add_u32 s30, s47, 8192
  buffer_load_dwordx4 v[44:47], v230, s[12:15], s30 offen sc1
  v_mfma_f32_16x16x32_bf16 v[100:103], a[16:19], v[148:151], 0
  s_add_u32 s60, s61, 409600
  buffer_load_dwordx4 a[200:203], v243, s[64:67], s60 offen sc1
  v_mfma_f32_16x16x32_bf16 v[120:123], a[16:19], v[152:155], 0
  buffer_load_dwordx4 a[204:207], v243, s[64:67], s60 offen offset:1024 sc1
  v_mfma_f32_16x16x32_bf16 v[140:143], a[16:19], v[156:159], 0
  s_waitcnt vmcnt(10)
  s_lshl_b32 s99, s3, 2
  s_add_u32 s99, s99, s20
  s_lshl_b32 s97, s99, 2
  s_add_u32 s97, s97, 8192
  v_mov_b32 v249, s90
  v_mov_b32 v254, 0
  s_mov_b64 exec, 1
  buffer_store_dword v249, v254, s[92:95], s97 offen sc1
  s_mov_b64 exec, -1
  s_waitcnt vmcnt(11)
  v_mfma_f32_16x16x32_bf16 v[64:67], a[20:23], v[160:163], v[64:67]
  v_mfma_f32_16x16x32_bf16 v[84:87], a[20:23], v[164:167], v[84:87]
  s_add_u32 s30, s44, 10240
  buffer_load_dwordx4 v[48:51], v230, s[12:15], s30 offen sc1
  v_mfma_f32_16x16x32_bf16 v[104:107], a[20:23], v[168:171], v[104:107]
  v_mfma_f32_16x16x32_bf16 v[124:127], a[20:23], v[172:175], v[124:127]
  v_mfma_f32_16x16x32_bf16 v[68:71], a[24:27], v[160:163], v[68:71]
  v_mfma_f32_16x16x32_bf16 v[88:91], a[24:27], v[164:167], v[88:91]
  v_mfma_f32_16x16x32_bf16 v[108:111], a[24:27], v[168:171], v[108:111]
  s_add_u32 s30, s45, 10240
  buffer_load_dwordx4 v[52:55], v230, s[12:15], s30 offen sc1
  v_mfma_f32_16x16x32_bf16 v[128:131], a[24:27], v[172:175], v[128:131]
  v_mfma_f32_16x16x32_bf16 v[72:75], a[28:31], v[160:163], v[72:75]
  v_mfma_f32_16x16x32_bf16 v[92:95], a[28:31], v[164:167], v[92:95]
  v_mfma_f32_16x16x32_bf16 v[112:115], a[28:31], v[168:171], v[112:115]
  v_mfma_f32_16x16x32_bf16 v[132:135], a[28:31], v[172:175], v[132:135]
  s_add_u32 s30, s46, 10240
  buffer_load_dwordx4 v[56:59], v230, s[12:15], s30 offen sc1
  v_mfma_f32_16x16x32_bf16 v[76:79], a[32:35], v[160:163], v[76:79]
  v_mfma_f32_16x16x32_bf16 v[96:99], a[32:35], v[164:167], v[96:99]
  v_mfma_f32_16x16x32_bf16 v[116:119], a[32:35], v[168:171], v[116:119]
  v_mfma_f32_16x16x32_bf16 v[136:139], a[32:35], v[172:175], v[136:139]
  v_mfma_f32_16x16x32_bf16 v[80:83], a[36:39], v[160:163], v[80:83]
  s_add_u32 s30, s47, 10240
  buffer_load_dwordx4 v[60:63], v230, s[12:15], s30 offen sc1
  v_mfma_f32_16x16x32_bf16 v[100:103], a[36:39], v[164:167], v[100:103]
  buffer_load_dwordx4 a[208:211], v243, s[64:67], s60 offen offset:2048 sc1
  v_mfma_f32_16x16x32_bf16 v[120:123], a[36:39], v[168:171], v[120:123]
  buffer_load_dwordx4 a[212:215], v243, s[64:67], s60 offen offset:3072 sc1
  v_mfma_f32_16x16x32_bf16 v[140:143], a[36:39], v[172:175], v[140:143]
  s_waitcnt vmcnt(17)
  v_mfma_f32_16x16x32_bf16 v[64:67], a[40:43], v[176:179], v[64:67]
  v_mfma_f32_16x16x32_bf16 v[84:87], a[40:43], v[180:183], v[84:87]
  s_add_u32 s30, s44, 12288
  buffer_load_dwordx4 v[192:195], v230, s[12:15], s30 offen sc1
  v_mfma_f32_16x16x32_bf16 v[104:107], a[40:43], v[184:187], v[104:107]
  v_mfma_f32_16x16x32_bf16 v[124:127], a[40:43], v[188:191], v[124:127]
  v_mfma_f32_16x16x32_bf16 v[68:71], a[44:47], v[176:179], v[68:71]
  v_mfma_f32_16x16x32_bf16 v[88:91], a[44:47], v[180:183], v[88:91]
  v_mfma_f32_16x16x32_bf16 v[108:111], a[44:47], v[184:187], v[108:111]
  s_add_u32 s30, s45, 12288
  buffer_load_dwordx4 v[196:199], v230, s[12:15], s30 offen sc1
  v_mfma_f32_16x16x32_bf16 v[128:131], a[44:47], v[188:191], v[128:131]
  v_mfma_f32_16x16x32_bf16 v[72:75], a[48:51], v[176:179], v[72:75]
  v_mfma_f32_16x16x32_bf16 v[92:95], a[48:51], v[180:183], v[92:95]
  v_mfma_f32_16x16x32_bf16 v[112:115], a[48:51], v[184:187], v[112:115]
  v_mfma_f32_16x16x32_bf16 v[132:135], a[48:51], v[188:191], v[132:135]
  s_add_u32 s30, s46, 12288
  buffer_load_dwordx4 v[200:203], v230, s[12:15], s30 offen sc1
  v_mfma_f32_16x16x32_bf16 v[76:79], a[52:55], v[176:179], v[76:79]
  v_mfma_f32_16x16x32_bf16 v[96:99], a[52:55], v[180:183], v[96:99]
  v_mfma_f32_16x16x32_bf16 v[116:119], a[52:55], v[184:187], v[116:119]
  v_mfma_f32_16x16x32_bf16 v[136:139], a[52:55], v[188:191], v[136:139]
  v_mfma_f32_16x16x32_bf16 v[80:83], a[56:59], v[176:179], v[80:83]
  s_add_u32 s30, s47, 12288
  buffer_load_dwordx4 v[204:207], v230, s[12:15], s30 offen sc1
  v_mfma_f32_16x16x32_bf16 v[100:103], a[56:59], v[180:183], v[100:103]
  s_add_u32 s60, s60, 4096
  buffer_load_dwordx4 a[216:219], v243, s[64:67], s60 offen sc1
  v_mfma_f32_16x16x32_bf16 v[120:123], a[56:59], v[184:187], v[120:123]
  s_add_u32 s60, s61, 450560
  buffer_load_dwordx4 a[220:223], v243, s[64:67], s60 offen sc1
  v_mfma_f32_16x16x32_bf16 v[140:143], a[56:59], v[188:191], v[140:143]
  s_waitcnt vmcnt(19)
  v_mfma_f32_16x16x32_bf16 v[64:67], a[60:63], v[16:19], v[64:67]
  v_mfma_f32_16x16x32_bf16 v[84:87], a[60:63], v[20:23], v[84:87]
  s_add_u32 s30, s44, 14336
  buffer_load_dwordx4 v[208:211], v230, s[12:15], s30 offen sc1
  v_mfma_f32_16x16x32_bf16 v[104:107], a[60:63], v[24:27], v[104:107]
  v_mfma_f32_16x16x32_bf16 v[124:127], a[60:63], v[28:31], v[124:127]
  v_mfma_f32_16x16x32_bf16 v[68:71], a[64:67], v[16:19], v[68:71]
  v_mfma_f32_16x16x32_bf16 v[88:91], a[64:67], v[20:23], v[88:91]
  v_mfma_f32_16x16x32_bf16 v[108:111], a[64:67], v[24:27], v[108:111]
  s_add_u32 s30, s45, 14336
  buffer_load_dwordx4 v[212:215], v230, s[12:15], s30 offen sc1
  v_mfma_f32_16x16x32_bf16 v[128:131], a[64:67], v[28:31], v[128:131]
  v_mfma_f32_16x16x32_bf16 v[72:75], a[68:71], v[16:19], v[72:75]
  v_mfma_f32_16x16x32_bf16 v[92:95], a[68:71], v[20:23], v[92:95]
  v_mfma_f32_16x16x32_bf16 v[112:115], a[68:71], v[24:27], v[112:115]
  v_mfma_f32_16x16x32_bf16 v[132:135], a[68:71], v[28:31], v[132:135]
  s_add_u32 s30, s46, 14336
  buffer_load_dwordx4 v[216:219], v230, s[12:15], s30 offen sc1
  v_mfma_f32_16x16x32_bf16 v[76:79], a[72:75], v[16:19], v[76:79]
  v_mfma_f32_16x16x32_bf16 v[96:99], a[72:75], v[20:23], v[96:99]
  v_mfma_f32_16x16x32_bf16 v[116:119], a[72:75], v[24:27], v[116:119]
  v_mfma_f32_16x16x32_bf16 v[136:139], a[72:75], v[28:31], v[136:139]
  v_mfma_f32_16x16x32_bf16 v[80:83], a[76:79], v[16:19], v[80:83]
  s_add_u32 s30, s47, 14336
  buffer_load_dwordx4 v[220:223], v230, s[12:15], s30 offen sc1
  v_mfma_f32_16x16x32_bf16 v[100:103], a[76:79], v[20:23], v[100:103]
  buffer_load_dwordx4 a[224:227], v243, s[64:67], s60 offen offset:1024 sc1
  v_mfma_f32_16x16x32_bf16 v[120:123], a[76:79], v[24:27], v[120:123]
  buffer_load_dwordx4 a[228:231], v243, s[64:67], s60 offen offset:2048 sc1
  v_mfma_f32_16x16x32_bf16 v[140:143], a[76:79], v[28:31], v[140:143]
  s_waitcnt vmcnt(21)
  v_mfma_f32_16x16x32_bf16 v[64:67], a[80:83], v[32:35], v[64:67]
  v_mfma_f32_16x16x32_bf16 v[84:87], a[80:83], v[36:39], v[84:87]
  s_add_u32 s30, s44, 16384
  buffer_load_dwordx4 v[144:147], v230, s[12:15], s30 offen sc1
  v_mfma_f32_16x16x32_bf16 v[104:107], a[80:83], v[40:43], v[104:107]
  v_mfma_f32_16x16x32_bf16 v[124:127], a[80:83], v[44:47], v[124:127]
  v_mfma_f32_16x16x32_bf16 v[68:71], a[84:87], v[32:35], v[68:71]
  v_mfma_f32_16x16x32_bf16 v[88:91], a[84:87], v[36:39], v[88:91]
  v_mfma_f32_16x16x32_bf16 v[108:111], a[84:87], v[40:43], v[108:111]
  s_add_u32 s30, s45, 16384
  buffer_load_dwordx4 v[148:151], v230, s[12:15], s30 offen sc1
  v_mfma_f32_16x16x32_bf16 v[128:131], a[84:87], v[44:47], v[128:131]
  v_mfma_f32_16x16x32_bf16 v[72:75], a[88:91], v[32:35], v[72:75]
  v_mfma_f32_16x16x32_bf16 v[92:95], a[88:91], v[36:39], v[92:95]
  v_mfma_f32_16x16x32_bf16 v[112:115], a[88:91], v[40:43], v[112:115]
  v_mfma_f32_16x16x32_bf16 v[132:135], a[88:91], v[44:47], v[132:135]
  s_add_u32 s30, s46, 16384
  buffer_load_dwordx4 v[152:155], v230, s[12:15], s30 offen sc1
  v_mfma_f32_16x16x32_bf16 v[76:79], a[92:95], v[32:35], v[76:79]
  v_mfma_f32_16x16x32_bf16 v[96:99], a[92:95], v[36:39], v[96:99]
  v_mfma_f32_16x16x32_bf16 v[116:119], a[92:95], v[40:43], v[116:119]
  v_mfma_f32_16x16x32_bf16 v[136:139], a[92:95], v[44:47], v[136:139]
  v_mfma_f32_16x16x32_bf16 v[80:83], a[96:99], v[32:35], v[80:83]
  s_add_u32 s30, s47, 16384
  buffer_load_dwordx4 v[156:159], v230, s[12:15], s30 offen sc1
  v_mfma_f32_16x16x32_bf16 v[100:103], a[96:99], v[36:39], v[100:103]
  buffer_load_dwordx4 a[232:235], v243, s[64:67], s60 offen offset:3072 sc1
  v_mfma_f32_16x16x32_bf16 v[120:123], a[96:99], v[40:43], v[120:123]
  s_add_u32 s60, s60, 4096
  buffer_load_dwordx4 a[236:239], v243, s[64:67], s60 offen sc1
  v_mfma_f32_16x16x32_bf16 v[140:143], a[96:99], v[44:47], v[140:143]
  s_waitcnt vmcnt(20)
  v_mfma_f32_16x16x32_bf16 v[64:67], a[100:103], v[48:51], v[64:67]
  v_mfma_f32_16x16x32_bf16 v[84:87], a[100:103], v[52:55], v[84:87]
  s_add_u32 s30, s44, 18432
  buffer_load_dwordx4 v[160:163], v230, s[12:15], s30 offen sc1
  v_mfma_f32_16x16x32_bf16 v[104:107], a[100:103], v[56:59], v[104:107]
  v_mfma_f32_16x16x32_bf16 v[124:127], a[100:103], v[60:63], v[124:127]
  v_mfma_f32_16x16x32_bf16 v[68:71], a[104:107], v[48:51], v[68:71]
  v_mfma_f32_16x16x32_bf16 v[88:91], a[104:107], v[52:55], v[88:91]
  v_mfma_f32_16x16x32_bf16 v[108:111], a[104:107], v[56:59], v[108:111]
  s_add_u32 s30, s45, 18432
  buffer_load_dwordx4 v[164:167], v230, s[12:15], s30 offen sc1
  v_mfma_f32_16x16x32_bf16 v[128:131], a[104:107], v[60:63], v[128:131]
  v_mfma_f32_16x16x32_bf16 v[72:75], a[108:111], v[48:51], v[72:75]
  v_mfma_f32_16x16x32_bf16 v[92:95], a[108:111], v[52:55], v[92:95]
  v_mfma_f32_16x16x32_bf16 v[112:115], a[108:111], v[56:59], v[112:115]
  v_mfma_f32_16x16x32_bf16 v[132:135], a[108:111], v[60:63], v[132:135]
  s_add_u32 s30, s46, 18432
  buffer_load_dwordx4 v[168:171], v230, s[12:15], s30 offen sc1
  v_mfma_f32_16x16x32_bf16 v[76:79], a[112:115], v[48:51], v[76:79]
  v_mfma_f32_16x16x32_bf16 v[96:99], a[112:115], v[52:55], v[96:99]
  v_mfma_f32_16x16x32_bf16 v[116:119], a[112:115], v[56:59], v[116:119]
  v_mfma_f32_16x16x32_bf16 v[136:139], a[112:115], v[60:63], v[136:139]
  v_mfma_f32_16x16x32_bf16 v[80:83], a[116:119], v[48:51], v[80:83]
  s_add_u32 s30, s47, 18432
  buffer_load_dwordx4 v[172:175], v230, s[12:15], s30 offen sc1
  v_mfma_f32_16x16x32_bf16 v[100:103], a[116:119], v[52:55], v[100:103]
  v_mfma_f32_16x16x32_bf16 v[120:123], a[116:119], v[56:59], v[120:123]
  v_mfma_f32_16x16x32_bf16 v[140:143], a[116:119], v[60:63], v[140:143]
  v_and_b32 v254, 63, v0
  s_and_b32 s97, s21, 15
  s_lshl_b32 s97, s97, 6
  v_add_u32 v254, s97, v254
  v_lshlrev_b32 v254, 2, v254
  s_mov_b32 s97, 8192
  buffer_load_dword v250, v254, s[92:95], s97 offen sc1
  s_waitcnt vmcnt(19)
  v_mfma_f32_16x16x32_bf16 v[64:67], a[120:123], v[192:195], v[64:67]
  v_mfma_f32_16x16x32_bf16 v[84:87], a[120:123], v[196:199], v[84:87]
  s_add_u32 s30, s44, 20480
  buffer_load_dwordx4 v[176:179], v230, s[12:15], s30 offen sc1
  v_mfma_f32_16x16x32_bf16 v[104:107], a[120:123], v[200:203], v[104:107]
  v_mfma_f32_16x16x32_bf16 v[124:127], a[120:123], v[204:207], v[124:127]
  v_mfma_f32_16x16x32_bf16 v[68:71], a[124:127], v[192:195], v[68:71]
  v_mfma_f32_16x16x32_bf16 v[88:91], a[124:127], v[196:199], v[88:91]
  v_mfma_f32_16x16x32_bf16 v[108:111], a[124:127], v[200:203], v[108:111]
  s_add_u32 s30, s45, 20480
  buffer_load_dwordx4 v[180:183], v230, s[12:15], s30 offen sc1
  v_mfma_f32_16x16x32_bf16 v[128:131], a[124:127], v[204:207], v[128:131]
  v_mfma_f32_16x16x32_bf16 v[72:75], a[128:131], v[192:195], v[72:75]
  v_mfma_f32_16x16x32_bf16 v[92:95], a[128:131], v[196:199], v[92:95]
  v_mfma_f32_16x16x32_bf16 v[112:115], a[128:131], v[200:203], v[112:115]
  v_mfma_f32_16x16x32_bf16 v[132:135], a[128:131], v[204:207], v[132:135]
  s_add_u32 s30, s46, 20480
  buffer_load_dwordx4 v[184:187], v230, s[12:15], s30 offen sc1
  v_mfma_f32_16x16x32_bf16 v[76:79], a[132:135], v[192:195], v[76:79]
  v_mfma_f32_16x16x32_bf16 v[96:99], a[132:135], v[196:199], v[96:99]
  v_mfma_f32_16x16x32_bf16 v[116:119], a[132:135], v[200:203], v[116:119]
  v_mfma_f32_16x16x32_bf16 v[136:139], a[132:135], v[204:207], v[136:139]
  v_mfma_f32_16x16x32_bf16 v[80:83], a[136:139], v[192:195], v[80:83]
  s_add_u32 s30, s47, 20480
  buffer_load_dwordx4 v[188:191], v230, s[12:15], s30 offen sc1
  v_mfma_f32_16x16x32_bf16 v[100:103], a[136:139], v[196:199], v[100:103]
  v_mfma_f32_16x16x32_bf16 v[120:123], a[136:139], v[200:203], v[120:123]
  v_mfma_f32_16x16x32_bf16 v[140:143], a[136:139], v[204:207], v[140:143]
  s_waitcnt vmcnt(17)
  v_mfma_f32_16x16x32_bf16 v[64:67], a[140:143], v[208:211], v[64:67]
  v_mfma_f32_16x16x32_bf16 v[84:87], a[140:143], v[212:215], v[84:87]
  s_add_u32 s30, s44, 22528
  buffer_load_dwordx4 v[16:19], v230, s[12:15], s30 offen sc1
  v_mfma_f32_16x16x32_bf16 v[104:107], a[140:143], v[216:219], v[104:107]
  v_mfma_f32_16x16x32_bf16 v[124:127], a[140:143], v[220:223], v[124:127]
  v_mfma_f32_16x16x32_bf16 v[68:71], a[144:147], v[208:211], v[68:71]
  v_mfma_f32_16x16x32_bf16 v[88:91], a[144:147], v[212:215], v[88:91]
  v_mfma_f32_16x16x32_bf16 v[108:111], a[144:147], v[216:219], v[108:111]
  s_add_u32 s30, s45, 22528
  buffer_load_dwordx4 v[20:23], v230, s[12:15], s30 offen sc1
  v_mfma_f32_16x16x32_bf16 v[128:131], a[144:147], v[220:223], v[128:131]
  v_mfma_f32_16x16x32_bf16 v[72:75], a[148:151], v[208:211], v[72:75]
  v_mfma_f32_16x16x32_bf16 v[92:95], a[148:151], v[212:215], v[92:95]
  v_mfma_f32_16x16x32_bf16 v[112:115], a[148:151], v[216:219], v[112:115]
  v_mfma_f32_16x16x32_bf16 v[132:135], a[148:151], v[220:223], v[132:135]
  s_add_u32 s30, s46, 22528
  buffer_load_dwordx4 v[24:27], v230, s[12:15], s30 offen sc1
  v_mfma_f32_16x16x32_bf16 v[76:79], a[152:155], v[208:211], v[76:79]
  v_mfma_f32_16x16x32_bf16 v[96:99], a[152:155], v[212:215], v[96:99]
  v_mfma_f32_16x16x32_bf16 v[116:119], a[152:155], v[216:219], v[116:119]
  v_mfma_f32_16x16x32_bf16 v[136:139], a[152:155], v[220:223], v[136:139]
  v_mfma_f32_16x16x32_bf16 v[80:83], a[156:159], v[208:211], v[80:83]
  s_add_u32 s30, s47, 22528
  buffer_load_dwordx4 v[28:31], v230, s[12:15], s30 offen sc1
  v_mfma_f32_16x16x32_bf16 v[100:103], a[156:159], v[212:215], v[100:103]
  v_mfma_f32_16x16x32_bf16 v[120:123], a[156:159], v[216:219], v[120:123]
  v_mfma_f32_16x16x32_bf16 v[140:143], a[156:159], v[220:223], v[140:143]
  s_waitcnt vmcnt(15)
  v_mfma_f32_16x16x32_bf16 v[64:67], a[160:163], v[144:147], v[64:67]
  v_mfma_f32_16x16x32_bf16 v[84:87], a[160:163], v[148:151], v[84:87]
  v_mfma_f32_16x16x32_bf16 v[104:107], a[160:163], v[152:155], v[104:107]
  v_mfma_f32_16x16x32_bf16 v[124:127], a[160:163], v[156:159], v[124:127]
  v_mfma_f32_16x16x32_bf16 v[68:71], a[164:167], v[144:147], v[68:71]
  v_mfma_f32_16x16x32_bf16 v[88:91], a[164:167], v[148:151], v[88:91]
  v_mfma_f32_16x16x32_bf16 v[108:111], a[164:167], v[152:155], v[108:111]
  v_mfma_f32_16x16x32_bf16 v[128:131], a[164:167], v[156:159], v[128:131]
  v_mfma_f32_16x16x32_bf16 v[72:75], a[168:171], v[144:147], v[72:75]
  v_mfma_f32_16x16x32_bf16 v[92:95], a[168:171], v[148:151], v[92:95]
  v_mfma_f32_16x16x32_bf16 v[112:115], a[168:171], v[152:155], v[112:115]
  v_mfma_f32_16x16x32_bf16 v[132:135], a[168:171], v[156:159], v[132:135]
  v_mfma_f32_16x16x32_bf16 v[76:79], a[172:175], v[144:147], v[76:79]
  v_mfma_f32_16x16x32_bf16 v[96:99], a[172:175], v[148:151], v[96:99]
  v_mfma_f32_16x16x32_bf16 v[116:119], a[172:175], v[152:155], v[116:119]
  v_mfma_f32_16x16x32_bf16 v[136:139], a[172:175], v[156:159], v[136:139]
  v_mfma_f32_16x16x32_bf16 v[80:83], a[176:179], v[144:147], v[80:83]
  v_mfma_f32_16x16x32_bf16 v[100:103], a[176:179], v[148:151], v[100:103]
  v_mfma_f32_16x16x32_bf16 v[120:123], a[176:179], v[152:155], v[120:123]
  v_mfma_f32_16x16x32_bf16 v[140:143], a[176:179], v[156:159], v[140:143]
  s_add_u32 s28, s20, 1
  s_and_b32 s28, s28, 3
  s_mul_i32 s28, s28, 15360
  s_add_u32 s28, s28, 0
  v_add_u32 v233, s28, v243
  s_add_u32 s28, s20, 2
  s_and_b32 s28, s28, 3
  s_mul_i32 s28, s28, 15360
  s_add_u32 s28, s28, 5120
  v_add_u32 v234, s28, v243
  s_add_u32 s28, s20, 3
  s_and_b32 s28, s28, 3
  s_mul_i32 s28, s28, 15360
  s_add_u32 s28, s28, 10240
  v_add_u32 v235, s28, v243
  s_mul_i32 s28, s20, 15360
  s_add_u32 s28, s28, 0
  v_add_u32 v236, s28, v243
  s_waitcnt vmcnt(9)
  v_mfma_f32_16x16x32_bf16 v[64:67], a[180:183], v[160:163], v[64:67]
  v_mfma_f32_16x16x32_bf16 v[84:87], a[180:183], v[164:167], v[84:87]
  v_mfma_f32_16x16x32_bf16 v[104:107], a[180:183], v[168:171], v[104:107]
  v_mfma_f32_16x16x32_bf16 v[124:127], a[180:183], v[172:175], v[124:127]
  v_mfma_f32_16x16x32_bf16 v[68:71], a[184:187], v[160:163], v[68:71]
  v_mfma_f32_16x16x32_bf16 v[88:91], a[184:187], v[164:167], v[88:91]
  v_mfma_f32_16x16x32_bf16 v[108:111], a[184:187], v[168:171], v[108:111]
  v_mfma_f32_16x16x32_bf16 v[128:131], a[184:187], v[172:175], v[128:131]
  v_mfma_f32_16x16x32_bf16 v[72:75], a[188:191], v[160:163], v[72:75]
  v_mfma_f32_16x16x32_bf16 v[92:95], a[188:191], v[164:167], v[92:95]
  v_mfma_f32_16x16x32_bf16 v[112:115], a[188:191], v[168:171], v[112:115]
  v_mfma_f32_16x16x32_bf16 v[132:135], a[188:191], v[172:175], v[132:135]
  v_mfma_f32_16x16x32_bf16 v[76:79], a[192:195], v[160:163], v[76:79]
  v_mfma_f32_16x16x32_bf16 v[96:99], a[192:195], v[164:167], v[96:99]
  v_mfma_f32_16x16x32_bf16 v[116:119], a[192:195], v[168:171], v[116:119]
  v_mfma_f32_16x16x32_bf16 v[136:139], a[192:195], v[172:175], v[136:139]
  v_mfma_f32_16x16x32_bf16 v[80:83], a[196:199], v[160:163], v[80:83]
  v_mfma_f32_16x16x32_bf16 v[100:103], a[196:199], v[164:167], v[100:103]
  v_mfma_f32_16x16x32_bf16 v[120:123], a[196:199], v[168:171], v[120:123]
  v_mfma_f32_16x16x32_bf16 v[140:143], a[196:199], v[172:175], v[140:143]
  s_waitcnt vmcnt(8)
  s_mov_b32 s96, 0
K_w9:
  v_cmp_ne_u32 vcc, s90, v250
  s_cbranch_vccz K_wok10
  s_add_u32 s96, s96, 1
  s_cmp_gt_u32 s96, 20000
  s_cbranch_scc1 K_wok10
  s_mov_b32 s97, 8192
  s_sleep 4
  buffer_load_dword v250, v254, s[92:95], s97 offen sc1
  s_waitcnt vmcnt(0)
  s_branch K_w9
K_wok10:
  buffer_load_dword v232, v232, s[40:43], 0 offen sc1
  buffer_load_dwordx2 v[244:245], v231, s[8:11], 0 offen offset:0 sc1
  buffer_load_dwordx2 v[246:247], v231, s[8:11], 0 offen offset:32 sc1
  buffer_load_dwordx2 v[248:249], v231, s[8:11], 0 offen offset:64 sc1
  buffer_load_dwordx2 v[250:251], v231, s[8:11], 0 offen offset:96 sc1
  buffer_load_dwordx2 v[252:253], v231, s[8:11], 0 offen offset:128 sc1
  s_waitcnt vmcnt(10)
  v_mfma_f32_16x16x32_bf16 v[64:67], a[200:203], v[176:179], v[64:67]
  v_mfma_f32_16x16x32_bf16 v[84:87], a[200:203], v[180:183], v[84:87]
  v_mfma_f32_16x16x32_bf16 v[104:107], a[200:203], v[184:187], v[104:107]
  v_mfma_f32_16x16x32_bf16 v[124:127], a[200:203], v[188:191], v[124:127]
  v_mfma_f32_16x16x32_bf16 v[68:71], a[204:207], v[176:179], v[68:71]
  v_mfma_f32_16x16x32_bf16 v[88:91], a[204:207], v[180:183], v[88:91]
  v_mfma_f32_16x16x32_bf16 v[108:111], a[204:207], v[184:187], v[108:111]
  v_mfma_f32_16x16x32_bf16 v[128:131], a[204:207], v[188:191], v[128:131]
  v_mfma_f32_16x16x32_bf16 v[72:75], a[208:211], v[176:179], v[72:75]
  v_mfma_f32_16x16x32_bf16 v[92:95], a[208:211], v[180:183], v[92:95]
  v_mfma_f32_16x16x32_bf16 v[112:115], a[208:211], v[184:187], v[112:115]
  v_mfma_f32_16x16x32_bf16 v[132:135], a[208:211], v[188:191], v[132:135]
  v_mfma_f32_16x16x32_bf16 v[76:79], a[212:215], v[176:179], v[76:79]
  v_mfma_f32_16x16x32_bf16 v[96:99], a[212:215], v[180:183], v[96:99]
  v_mfma_f32_16x16x32_bf16 v[116:119], a[212:215], v[184:187], v[116:119]
  v_mfma_f32_16x16x32_bf16 v[136:139], a[212:215], v[188:191], v[136:139]
  v_mfma_f32_16x16x32_bf16 v[80:83], a[216:219], v[176:179], v[80:83]
  v_mfma_f32_16x16x32_bf16 v[100:103], a[216:219], v[180:183], v[100:103]
  v_mfma_f32_16x16x32_bf16 v[120:123], a[216:219], v[184:187], v[120:123]
  v_mfma_f32_16x16x32_bf16 v[140:143], a[216:219], v[188:191], v[140:143]
  s_waitcnt vmcnt(6)
  v_mfma_f32_16x16x32_bf16 v[84:87], a[220:223], v[20:23], v[84:87]
  v_mfma_f32_16x16x32_bf16 v[88:91], a[224:227], v[20:23], v[88:91]
  v_mfma_f32_16x16x32_bf16 v[92:95], a[228:231], v[20:23], v[92:95]
  v_mfma_f32_16x16x32_bf16 v[96:99], a[232:235], v[20:23], v[96:99]
  v_mfma_f32_16x16x32_bf16 v[100:103], a[236:239], v[20:23], v[100:103]
  v_mfma_f32_16x16x32_bf16 v[104:107], a[220:223], v[24:27], v[104:107]
  v_mfma_f32_16x16x32_bf16 v[108:111], a[224:227], v[24:27], v[108:111]
  v_mfma_f32_16x16x32_bf16 v[112:115], a[228:231], v[24:27], v[112:115]
  v_mfma_f32_16x16x32_bf16 v[116:119], a[232:235], v[24:27], v[116:119]
  v_mfma_f32_16x16x32_bf16 v[120:123], a[236:239], v[24:27], v[120:123]
  v_mfma_f32_16x16x32_bf16 v[124:127], a[220:223], v[28:31], v[124:127]
  ds_write_b128 v233, v[84:87] offset:0
  v_mfma_f32_16x16x32_bf16 v[128:131], a[224:227], v[28:31], v[128:131]
  ds_write_b128 v233, v[88:91] offset:1024
  v_mfma_f32_16x16x32_bf16 v[132:135], a[228:231], v[28:31], v[132:135]
  ds_write_b128 v233, v[92:95] offset:2048
  v_mfma_f32_16x16x32_bf16 v[136:139], a[232:235], v[28:31], v[136:139]
  ds_write_b128 v233, v[96:99] offset:3072
  v_mfma_f32_16x16x32_bf16 v[140:143], a[236:239], v[28:31], v[140:143]
  ds_write_b128 v233, v[100:103] offset:4096
  v_mfma_f32_16x16x32_bf16 v[64:67], a[220:223], v[16:19], v[64:67]
  ds_write_b128 v234, v[104:107] offset:0
  v_mfma_f32_16x16x32_bf16 v[68:71], a[224:227], v[16:19], v[68:71]
  ds_write_b128 v234, v[108:111] offset:1024
  v_mfma_f32_16x16x32_bf16 v[72:75], a[228:231], v[16:19], v[72:75]
  ds_write_b128 v234, v[112:115] offset:2048
  v_mfma_f32_16x16x32_bf16 v[76:79], a[232:235], v[16:19], v[76:79]
  ds_write_b128 v234, v[116:119] offset:3072
  v_mfma_f32_16x16x32_bf16 v[80:83], a[236:239], v[16:19], v[80:83]
  ds_write_b128 v234, v[120:123] offset:4096
  ds_write_b128 v235, v[124:127] offset:0
  ds_write_b128 v235, v[128:131] offset:1024
  ds_write_b128 v235, v[132:135] offset:2048
  ds_write_b128 v235, v[136:139] offset:3072
  ds_write_b128 v235, v[140:143] offset:4096
  s_waitcnt lgkmcnt(0)
  s_barrier
  ds_read_b128 v[84:87], v236 offset:0
  ds_read_b128 v[88:91], v236 offset:1024
  ds_read_b128 v[92:95], v236 offset:2048
  ds_read_b128 v[96:99], v236 offset:3072
  ds_read_b128 v[100:103], v236 offset:4096
  ds_read_b128 v[104:107], v236 offset:5120
  ds_read_b128 v[108:111], v236 offset:6144
  ds_read_b128 v[112:115], v236 offset:7168
  ds_read_b128 v[116:119], v236 offset:8192
  ds_read_b128 v[120:123], v236 offset:9216
  ds_read_b128 v[124:127], v236 offset:10240
  ds_read_b128 v[128:131], v236 offset:11264
  ds_read_b128 v[132:135], v236 offset:12288
  ds_read_b128 v[136:139], v236 offset:13312
  ds_read_b128 v[140:143], v236 offset:14336
  s_waitcnt vmcnt(0)
  v_sub_f32 v232, 1.0, v232
  v_cvt_pk_bf16_f32 v232, v232, v232
  v_and_b32 v232, 0xffff0000, v232
  s_waitcnt lgkmcnt(0)
  v_pk_add_f32 v[64:65], v[64:65], v[84:85]
  v_pk_add_f32 v[66:67], v[66:67], v[86:87]
  v_pk_add_f32 v[64:65], v[64:65], v[104:105]
  v_pk_add_f32 v[66:67], v[66:67], v[106:107]
  v_pk_add_f32 v[64:65], v[64:65], v[124:125]
  v_pk_add_f32 v[66:67], v[66:67], v[126:127]
  v_lshlrev_b32 v16, 16, v244
  v_and_b32 v17, 0xffff0000, v244
  v_lshlrev_b32 v18, 16, v245
  v_and_b32 v19, 0xffff0000, v245
  v_fmac_f32 v16, v232, v64
  v_fmac_f32 v17, v232, v65
  v_fmac_f32 v18, v232, v66
  v_fmac_f32 v19, v232, v67
  v_cvt_pk_bf16_f32 v20, v16, v17
  v_cvt_pk_bf16_f32 v21, v18, v19
  buffer_store_dwordx2 v[20:21], v231, s[36:39], 0 offen offset:0
  v_pk_add_f32 v[68:69], v[68:69], v[88:89]
  v_pk_add_f32 v[70:71], v[70:71], v[90:91]
  v_pk_add_f32 v[68:69], v[68:69], v[108:109]
  v_pk_add_f32 v[70:71], v[70:71], v[110:111]
  v_pk_add_f32 v[68:69], v[68:69], v[128:129]
  v_pk_add_f32 v[70:71], v[70:71], v[130:131]
  v_lshlrev_b32 v16, 16, v246
  v_and_b32 v17, 0xffff0000, v246
  v_lshlrev_b32 v18, 16, v247
  v_and_b32 v19, 0xffff0000, v247
  v_fmac_f32 v16, v232, v68
  v_fmac_f32 v17, v232, v69
  v_fmac_f32 v18, v232, v70
  v_fmac_f32 v19, v232, v71
  v_cvt_pk_bf16_f32 v22, v16, v17
  v_cvt_pk_bf16_f32 v23, v18, v19
  buffer_store_dwordx2 v[22:23], v231, s[36:39], 0 offen offset:32
  v_pk_add_f32 v[72:73], v[72:73], v[92:93]
  v_pk_add_f32 v[74:75], v[74:75], v[94:95]
  v_pk_add_f32 v[72:73], v[72:73], v[112:113]
  v_pk_add_f32 v[74:75], v[74:75], v[114:115]
  v_pk_add_f32 v[72:73], v[72:73], v[132:133]
  v_pk_add_f32 v[74:75], v[74:75], v[134:135]
  v_lshlrev_b32 v16, 16, v248
  v_and_b32 v17, 0xffff0000, v248
  v_lshlrev_b32 v18, 16, v249
  v_and_b32 v19, 0xffff0000, v249
  v_fmac_f32 v16, v232, v72
  v_fmac_f32 v17, v232, v73
  v_fmac_f32 v18, v232, v74
  v_fmac_f32 v19, v232, v75
  v_cvt_pk_bf16_f32 v24, v16, v17
  v_cvt_pk_bf16_f32 v25, v18, v19
  buffer_store_dwordx2 v[24:25], v231, s[36:39], 0 offen offset:64
  v_pk_add_f32 v[76:77], v[76:77], v[96:97]
  v_pk_add_f32 v[78:79], v[78:79], v[98:99]
  v_pk_add_f32 v[76:77], v[76:77], v[116:117]
  v_pk_add_f32 v[78:79], v[78:79], v[118:119]
  v_pk_add_f32 v[76:77], v[76:77], v[136:137]
  v_pk_add_f32 v[78:79], v[78:79], v[138:139]
  v_lshlrev_b32 v16, 16, v250
  v_and_b32 v17, 0xffff0000, v250
  v_lshlrev_b32 v18, 16, v251
  v_and_b32 v19, 0xffff0000, v251
  v_fmac_f32 v16, v232, v76
  v_fmac_f32 v17, v232, v77
  v_fmac_f32 v18, v232, v78
  v_fmac_f32 v19, v232, v79
  v_cvt_pk_bf16_f32 v26, v16, v17
  v_cvt_pk_bf16_f32 v27, v18, v19
  buffer_store_dwordx2 v[26:27], v231, s[36:39], 0 offen offset:96
  v_pk_add_f32 v[80:81], v[80:81], v[100:101]
  v_pk_add_f32 v[82:83], v[82:83], v[102:103]
  v_pk_add_f32 v[80:81], v[80:81], v[120:121]
  v_pk_add_f32 v[82:83], v[82:83], v[122:123]
  v_pk_add_f32 v[80:81], v[80:81], v[140:141]
  v_pk_add_f32 v[82:83], v[82:83], v[142:143]
  v_lshlrev_b32 v16, 16, v252
  v_and_b32 v17, 0xffff0000, v252
  v_lshlrev_b32 v18, 16, v253
  v_and_b32 v19, 0xffff0000, v253
  v_fmac_f32 v16, v232, v80
  v_fmac_f32 v17, v232, v81
  v_fmac_f32 v18, v232, v82
  v_fmac_f32 v19, v232, v83
  v_cvt_pk_bf16_f32 v28, v16, v17
  v_cvt_pk_bf16_f32 v29, v18, v19
  buffer_store_dwordx2 v[28:29], v231, s[36:39], 0 offen offset:128
  s_endpgm
K_exit:
  s_endpgm
.section .rodata,"a"
.p2align 6
.amdhsa_kernel gated_mix__spectral_gfnet__swiglu_ffn__prompt_kernel
  .amdhsa_next_free_vgpr 512
  .amdhsa_next_free_sgpr 102
  .amdhsa_accum_offset 256
  .amdhsa_group_segment_fixed_size 0
  .amdhsa_kernarg_size 88
  .amdhsa_user_sgpr_count 2
  .amdhsa_user_sgpr_kernarg_segment_ptr 1
  .amdhsa_system_sgpr_workgroup_id_x 1
.end_amdhsa_kernel
```
